```python
import torch

def _softmax(x, axis=-1):
    return torch.softmax(x, dim=axis)
def _gelu(x):
    return torch.nn.functional.gelu(x, approximate="tanh")
def _silu(x):
    return torch.nn.functional.silu(x)
def _sigmoid(x):
    return torch.sigmoid(x)
def _layernorm(x, axis=-1, eps=1e-5):
    m = x.mean(dim=axis, keepdim=True)
    v = x.var(dim=axis, keepdim=True, unbiased=False)
    return (x - m) / torch.sqrt(v + eps)
def _scatter_add(tgt, idx, src, axis=0):
    return tgt.clone().index_add_(axis, idx, src)
def _segment_sum(src, seg, n):
    out = torch.zeros((n,) + src.shape[1:], dtype=src.dtype)
    return out.index_add_(0, seg, src)
def _pad(x, pw):
    flat = tuple(v for pair in reversed(pw) for v in pair)
    return torch.nn.functional.pad(x, flat)

kernel_name = 'interleave_layers__sliding_block_cached__glu_gated_glu__decode'

def setup_inputs():

    _w = (lambda a: (lambda t: t.to(torch.bfloat16) if t.is_floating_point() else t)(torch.as_tensor(a)))
    def _A_setup():
        B, Sq, D = 8, 1, 448
        Hq, Hkv, Sk, Dh = 16, 8, 4096, 256
        assert Hq % Hkv == 0, (Hq, Hkv)
        return {
            "x": _w((lambda *s: torch.randn(*s, dtype=torch.bfloat16) * 0.05)(B, Sq, D)),
            "k_cache": _w((lambda *s: torch.randn(*s, dtype=torch.bfloat16) * 1.6)(B, Hkv, Sk, Dh)),
            "v_cache": _w((lambda *s: torch.randn(*s, dtype=torch.bfloat16) * 1.6)(B, Hkv, Sk, Dh)),
            "wq": _w((lambda *s: torch.randn(*s, dtype=torch.bfloat16) * 1.6)(D, Hq * Dh) * (D ** -0.5)),
            "wo": _w((lambda *s: torch.randn(*s, dtype=torch.bfloat16) * 1.6)(Hq * Dh, D) * ((Hq * Dh) ** -0.5)),
        }
    _A_in = _A_setup()

    def _B_setup():
        B, S, D, F = 8, 1, 448, 1792
        return {
            "x": _w((lambda *s: torch.randn(*s, dtype=torch.bfloat16) * 0.05)(B, S, D)),
            "w_gate": _w((lambda *s: torch.randn(*s, dtype=torch.bfloat16) * 0.05)(D, F)),
            "w_up": _w((lambda *s: torch.randn(*s, dtype=torch.bfloat16) * 0.05)(D, F)),
            "w_down": _w((lambda *s: torch.randn(*s, dtype=torch.bfloat16) * 0.05)(F, D)),
        }
    _B_in = _B_setup()

    return {
        "A_x": _A_in["x"],
        "A_k_cache": _A_in["k_cache"],
        "A_v_cache": _A_in["v_cache"],
        "A_wq": _A_in["wq"],
        "A_wo": _A_in["wo"],
        "B_x": _B_in["x"],
        "B_w_gate": _B_in["w_gate"],
        "B_w_up": _B_in["w_up"],
        "B_w_down": _B_in["w_down"],
    }

def reference(A_x, A_k_cache, A_v_cache, A_wq, A_wo, B_x, B_w_gate, B_w_up, B_w_down):
    def _A_ref(x, k_cache, v_cache, wq, wo):
        B, Sq, D = x.shape
        Hq, Dh = 16, 256
        Hkv, Sk = k_cache.shape[1], k_cache.shape[2]
        W = min(4096, max(256, Sk // 4))
        rep = Hq // Hkv
        q = (lambda x, *d: x.permute(*d))((x @ wq).reshape(B, Sq, Hq, Dh), 0, 2, 1, 3)
        k = (lambda x, n, axis: torch.repeat_interleave(x, n, dim=axis))(k_cache[:, :, Sk - W:, :], rep, axis=1)
        v = (lambda x, n, axis: torch.repeat_interleave(x, n, dim=axis))(v_cache[:, :, Sk - W:, :], rep, axis=1)
        scores = torch.einsum("bhqd,bhkd->bhqk", q, k) * (Dh ** -0.5)
        p = _softmax(scores, axis=-1)
        o = torch.einsum("bhqk,bhkd->bhqd", p, v)
        return (lambda x, *d: x.permute(*d))(o, 0, 2, 1, 3).reshape(B, Sq, Hq * Dh) @ wo

    def _B_ref(x, w_gate, w_up, w_down):
        g = torch.einsum("bsd,df->bsf", x, w_gate)
        u = torch.einsum("bsd,df->bsf", x, w_up)
        h = _sigmoid(g) * u
        return torch.einsum("bsf,fd->bsd", h, w_down)

    x = A_x
    x = x + _A_ref(_layernorm(x, axis=-1), A_k_cache, A_v_cache, A_wq, A_wo)
    x = x + _B_ref(_layernorm(x, axis=-1), B_w_gate, B_w_up, B_w_down)
    x = x + _A_ref(_layernorm(x, axis=-1), A_k_cache, A_v_cache, A_wq, A_wo)
    x = x + _B_ref(_layernorm(x, axis=-1), B_w_gate, B_w_up, B_w_down)
    return x
```

```asm
; @launch grid=(256,1,1) block=(512,1,1) lds=110592
.amdgcn_target "amdgcn-amd-amdhsa--gfx950"
.text
.globl interleave_layers__sliding_block_cached__glu_gated_glu__decode_kernel
.p2align 8
.type interleave_layers__sliding_block_cached__glu_gated_glu__decode_kernel,@function
interleave_layers__sliding_block_cached__glu_gated_glu__decode_kernel:
  s_cmp_ge_u32 s2, 256
  s_cbranch_scc1 L_exit
  s_load_dwordx16 s[4:19], s[0:1], 0
  s_load_dwordx8 s[20:27], s[0:1], 64
  v_readfirstlane_b32 s30, v0
  s_and_b32 s28, s2, 7
  s_lshr_b32 s29, s2, 3
  v_and_b32 v0, 63, v0
  s_lshr_b32 s30, s30, 6
  s_cmp_eq_u32 s30, 0
  s_cbranch_scc0 L_others
  s_setprio 3
  s_and_b32 s49, s29, 1
  s_mul_i32 s49, s49, 1835008
  s_lshl_b32 s50, s28, 10
  s_add_u32 s49, s49, s50
  s_lshr_b32 s50, s29, 1
  s_lshl_b32 s50, s50, 6
  s_add_u32 s49, s49, s50
  v_lshrrev_b32 v106, 2, v0
  v_mul_u32_u24 v106, 8192, v106
  v_and_b32 v107, 3, v0
  v_lshl_add_u32 v106, v107, 4, v106
  v_add_u32 v106, s49, v106
  v_lshlrev_b32 v102, 4, v0
  v_mov_b32 v103, 70784
  v_mov_b32 v104, 0
  v_mov_b32 v105, 0
  ds_write_b64 v103, v[104:105] offset:8
  ds_write_b64 v103, v[104:105] offset:24
  s_waitcnt lgkmcnt(0)
  s_mov_b32 m0, 54272
  s_nop 0
  global_load_lds_dwordx4 v102, s[4:5]
  v_add_u32 v102, 1024, v102
  s_mov_b32 m0, 55296
  s_nop 0
  global_load_lds_dwordx4 v102, s[4:5]
  v_add_u32 v102, 1024, v102
  s_mov_b32 m0, 56320
  s_nop 0
  global_load_lds_dwordx4 v102, s[4:5]
  v_add_u32 v102, 1024, v102
  s_mov_b32 m0, 57344
  s_nop 0
  global_load_lds_dwordx4 v102, s[4:5]
  v_add_u32 v102, 1024, v102
  s_mov_b32 m0, 58368
  s_nop 0
  global_load_lds_dwordx4 v102, s[4:5]
  v_add_u32 v102, 1024, v102
  s_mov_b32 m0, 59392
  s_nop 0
  global_load_lds_dwordx4 v102, s[4:5]
  v_add_u32 v102, 1024, v102
  s_mov_b32 m0, 60416
  s_nop 0
  global_load_lds_dwordx4 v102, s[4:5]
  s_mov_b32 m0, 0
  s_nop 0
  global_load_lds_dwordx4 v106, s[10:11] nt
  v_add_u32 v106, 131072, v106
  s_mov_b32 m0, 1024
  s_nop 0
  global_load_lds_dwordx4 v106, s[10:11] nt
  v_add_u32 v106, 131072, v106
  s_mov_b32 m0, 2048
  s_nop 0
  global_load_lds_dwordx4 v106, s[10:11] nt
  v_add_u32 v106, 131072, v106
  s_mov_b32 m0, 3072
  s_nop 0
  global_load_lds_dwordx4 v106, s[10:11] nt
  v_add_u32 v106, 131072, v106
  s_mov_b32 m0, 4096
  s_nop 0
  global_load_lds_dwordx4 v106, s[10:11] nt
  v_add_u32 v106, 131072, v106
  s_mov_b32 m0, 5120
  s_nop 0
  global_load_lds_dwordx4 v106, s[10:11] nt
  v_add_u32 v106, 131072, v106
  s_mov_b32 m0, 6144
  s_nop 0
  global_load_lds_dwordx4 v106, s[10:11] nt
  v_add_u32 v106, 131072, v106
  s_mov_b32 m0, 7168
  s_nop 0
  global_load_lds_dwordx4 v106, s[10:11] nt
  v_add_u32 v106, 131072, v106
  s_mov_b32 m0, 8192
  s_nop 0
  global_load_lds_dwordx4 v106, s[10:11] nt
  v_add_u32 v106, 131072, v106
  s_mov_b32 m0, 9216
  s_nop 0
  global_load_lds_dwordx4 v106, s[10:11] nt
  v_add_u32 v106, 131072, v106
  s_mov_b32 m0, 10240
  s_nop 0
  global_load_lds_dwordx4 v106, s[10:11] nt
  v_add_u32 v106, 131072, v106
  s_mov_b32 m0, 11264
  s_nop 0
  global_load_lds_dwordx4 v106, s[10:11] nt
  v_add_u32 v106, 131072, v106
  s_mov_b32 m0, 12288
  s_nop 0
  global_load_lds_dwordx4 v106, s[10:11] nt
  v_add_u32 v106, 131072, v106
  s_mov_b32 m0, 13312
  s_nop 0
  global_load_lds_dwordx4 v106, s[10:11] nt
  s_barrier
  s_branch L_chain_pro
L_others:
  s_cmp_eq_u32 s30, 7
  s_cbranch_scc0 L_pre_done
  s_setprio 3
  s_mul_i32 s49, s2, 5120
  s_add_u32 s49, s49, 2048
  v_lshlrev_b32 v108, 4, v0
  v_add_u32 v108, s49, v108
  v_mov_b32 v112, -1
  v_mov_b32 v113, -1
  v_mov_b32 v114, -1
  v_mov_b32 v115, -1
  s_waitcnt lgkmcnt(0)
  global_store_dwordx4 v108, v[112:115], s[26:27] offset:-2048 sc1
  global_store_dwordx4 v108, v[112:115], s[26:27] offset:-1024 sc1
  global_store_dwordx4 v108, v[112:115], s[26:27] offset:0 sc1
  global_store_dwordx4 v108, v[112:115], s[26:27] offset:1024 sc1
  global_store_dwordx4 v108, v[112:115], s[26:27] offset:2048 sc1
  s_add_u32 s46, s26, 1638400
  s_addc_u32 s47, s27, 0
  s_load_dword s3, s[46:47], 0
L_pre_done:
  s_cmp_eq_u32 s30, 6
  s_cbranch_scc0 L_nocw
  s_cmp_lt_u32 s29, 3
  s_cbranch_scc0 L_nocw
  s_getpc_b64 s[46:47]
L_here:
  s_lshl_b32 s49, s29, 13
  v_lshlrev_b32 v108, 7, v0
  v_add_u32 v108, s49, v108
  v_min_u32 v108, L_end-L_here-4, v108
  global_load_dword v109, v108, s[46:47]
L_nocw:
  s_lshr_b32 s48, s29, 2
  s_lshl_b32 s48, s48, 24
  s_lshl_b32 s49, s28, 21
  s_add_u32 s48, s48, s49
  s_and_b32 s49, s29, 3
  s_lshl_b32 s49, s49, 17
  s_add_u32 s48, s48, s49
  s_lshl_b32 s49, s30, 14
  s_add_u32 s48, s48, s49
  s_add_u32 s48, s48, 1572864
  v_and_b32 v102, 15, v0
  v_lshrrev_b32 v103, 4, v0
  v_mov_b32 v94, 0
  v_and_b32 v96, 3, v102
  v_lshlrev_b32 v96, 11, v96
  v_lshrrev_b32 v97, 2, v102
  v_lshl_add_u32 v96, v97, 9, v96
  v_lshl_add_u32 v96, v103, 4, v96
  v_add_u32 v96, s48, v96
  v_add_u32 v97, 8192, v96
  v_lshlrev_b32 v98, 4, v102
  v_lshl_add_u32 v98, v103, 9, v98
  v_add_u32 v98, s48, v98
  v_add_u32 v98, 4096, v98
  v_add_u32 v99, 8192, v98
  s_getreg_b32 s34, hwreg(HW_REG_XCC_ID, 0, 4)
  s_and_b32 s34, s34, 7
  s_waitcnt lgkmcnt(0)
  s_barrier
  s_cmp_lt_u32 s30, 4
  s_cbranch_scc1 L_kvload
  s_cmp_eq_u32 s30, 7
  s_cbranch_scc0 L_kv0
  s_mul_i32 s3, s3, 0x9e3779b1
  s_add_u32 s3, s3, 0x7f4a7c15
  v_mov_b32 v102, s34
  v_mov_b32 v103, s3
  s_lshl_b32 s49, s2, 3
  s_add_u32 s49, s49, 1572864
  v_mov_b32 v104, s49
  s_waitcnt vmcnt(0)
  s_mov_b64 exec, 1
  global_store_dwordx2 v104, v[102:103], s[26:27] sc1
  s_mov_b64 exec, -1
  s_setprio 0
L_kv0:
  s_mov_b32 s32, 0
  s_mov_b32 s33, 0
  s_mov_b32 s66, 0
  s_cmp_lt_u32 s29, 28
  s_cselect_b32 s67, s30, 0
  s_cmp_ge_u32 s29, 14
  s_cselect_b32 s37, 1, 0
  s_mul_i32 s49, s37, 14
  s_sub_u32 s38, s29, s49
  s_mov_b32 s60, 0x3db8aa3b
  s_lshr_b32 s36, s34, 2
  s_xor_b32 s36, s36, 0
  s_lshl_b32 s36, s36, 13
  s_mov_b64 s[40:41], s[26:27]
  s_add_u32 s44, s26, 16384
  s_addc_u32 s45, s27, 0
  s_add_u32 s42, s26, 16384
  s_addc_u32 s43, s27, 0
  v_and_b32 v102, 15, v0
  v_lshrrev_b32 v103, 4, v0
  v_and_b32 v100, 1, v102
  v_lshlrev_b32 v100, 4, v100
  v_mov_b32 v101, 0xffff
  v_lshlrev_b32 v101, v100, v101
  v_bfe_u32 v100, v102, 1, 2
  v_cmp_eq_u32 vcc, 0, v100
  s_nop 1
  v_cndmask_b32 v4, 0, v101, vcc
  v_cmp_eq_u32 vcc, 1, v100
  s_nop 1
  v_cndmask_b32 v5, 0, v101, vcc
  v_cmp_eq_u32 vcc, 2, v100
  s_nop 1
  v_cndmask_b32 v6, 0, v101, vcc
  v_cmp_eq_u32 vcc, 3, v100
  s_nop 1
  v_cndmask_b32 v7, 0, v101, vcc
  v_lshrrev_b32 v100, 3, v102
  v_lshlrev_b32 v8, 9, v100
  v_bfe_u32 v101, v102, 2, 1
  v_lshl_add_u32 v8, v101, 10, v8
  v_lshl_add_u32 v8, v103, 4, v8
  v_add_u32 v8, 52224, v8
  v_lshrrev_b32 v101, 1, v103
  v_lshlrev_b32 v9, 10, v101
  v_lshl_add_u32 v9, v102, 5, v9
  v_and_b32 v101, 1, v103
  v_lshl_add_u32 v9, v101, 4, v9
  s_lshl_b32 s49, s30, 11
  s_add_u32 s49, s49, 54272
  v_add_u32 v9, s49, v9
  s_lshl_b32 s49, s30, 3
  s_add_u32 s49, s49, 70656
  v_lshlrev_b32 v10, 6, v100
  v_add_u32 v10, s49, v10
  s_lshl_b32 s49, s30, 14
  s_and_b32 s50, s30, 1
  s_lshl_b32 s50, s50, 13
  s_sub_u32 s49, s50, s49
  s_and_b32 s50, s30, 3
  s_lshl_b32 s50, s50, 13
  s_add_u32 s50, s50, 71680
  s_cmp_ge_u32 s30, 6
  s_cbranch_scc1 L_kv0_v
  v_add_u32 v100, s49, v96
  s_add_u32 m0, s50, 0
  s_nop 0
  global_load_lds_dwordx4 v100, s[6:7] nt
  v_add_u32 v100, 64, v100
  s_add_u32 m0, s50, 1024
  s_nop 0
  global_load_lds_dwordx4 v100, s[6:7] nt
  v_add_u32 v100, 64, v100
  s_add_u32 m0, s50, 2048
  s_nop 0
  global_load_lds_dwordx4 v100, s[6:7] nt
  v_add_u32 v100, 64, v100
  s_add_u32 m0, s50, 3072
  s_nop 0
  global_load_lds_dwordx4 v100, s[6:7] nt
  v_add_u32 v100, 64, v100
  s_add_u32 m0, s50, 4096
  s_nop 0
  global_load_lds_dwordx4 v100, s[6:7] nt
  v_add_u32 v100, 64, v100
  s_add_u32 m0, s50, 5120
  s_nop 0
  global_load_lds_dwordx4 v100, s[6:7] nt
  v_add_u32 v100, 64, v100
  s_add_u32 m0, s50, 6144
  s_nop 0
  global_load_lds_dwordx4 v100, s[6:7] nt
  v_add_u32 v100, 64, v100
  s_add_u32 m0, s50, 7168
  s_nop 0
  global_load_lds_dwordx4 v100, s[6:7] nt
  s_branch L_kvload
L_kv0_v:
  s_sub_u32 s49, s49, 4096
  v_add_u32 v100, s49, v98
  s_add_u32 m0, s50, 0
  s_nop 0
  global_load_lds_dwordx4 v100, s[8:9] nt
  v_add_u32 v100, 256, v100
  s_add_u32 m0, s50, 1024
  s_nop 0
  global_load_lds_dwordx4 v100, s[8:9] nt
  v_add_u32 v100, 1792, v100
  s_add_u32 m0, s50, 2048
  s_nop 0
  global_load_lds_dwordx4 v100, s[8:9] nt
  v_add_u32 v100, 256, v100
  s_add_u32 m0, s50, 3072
  s_nop 0
  global_load_lds_dwordx4 v100, s[8:9] nt
  v_add_u32 v100, 1792, v100
  s_add_u32 m0, s50, 4096
  s_nop 0
  global_load_lds_dwordx4 v100, s[8:9] nt
  v_add_u32 v100, 256, v100
  s_add_u32 m0, s50, 5120
  s_nop 0
  global_load_lds_dwordx4 v100, s[8:9] nt
  v_add_u32 v100, 1792, v100
  s_add_u32 m0, s50, 6144
  s_nop 0
  global_load_lds_dwordx4 v100, s[8:9] nt
  v_add_u32 v100, 256, v100
  s_add_u32 m0, s50, 7168
  s_nop 0
  global_load_lds_dwordx4 v100, s[8:9] nt
L_kvload:
  global_load_dwordx4 v[128:131], v96, s[6:7] offset:0 nt
  global_load_dwordx4 v[132:135], v96, s[6:7] offset:64 nt
  global_load_dwordx4 v[136:139], v96, s[6:7] offset:128 nt
  global_load_dwordx4 v[140:143], v96, s[6:7] offset:192 nt
  global_load_dwordx4 v[144:147], v96, s[6:7] offset:256 nt
  global_load_dwordx4 v[148:151], v96, s[6:7] offset:320 nt
  global_load_dwordx4 v[152:155], v96, s[6:7] offset:384 nt
  global_load_dwordx4 v[156:159], v96, s[6:7] offset:448 nt
  global_load_dwordx4 v[160:163], v97, s[6:7] offset:0 nt
  global_load_dwordx4 v[164:167], v97, s[6:7] offset:64 nt
  global_load_dwordx4 v[168:171], v97, s[6:7] offset:128 nt
  global_load_dwordx4 v[172:175], v97, s[6:7] offset:192 nt
  global_load_dwordx4 v[176:179], v97, s[6:7] offset:256 nt
  global_load_dwordx4 v[180:183], v97, s[6:7] offset:320 nt
  global_load_dwordx4 v[184:187], v97, s[6:7] offset:384 nt
  global_load_dwordx4 v[188:191], v97, s[6:7] offset:448 nt
  global_load_dwordx4 v[192:195], v98, s[8:9] offset:-4096 nt
  global_load_dwordx4 v[196:199], v98, s[8:9] offset:-3840 nt
  global_load_dwordx4 v[200:203], v98, s[8:9] offset:-2048 nt
  global_load_dwordx4 v[204:207], v98, s[8:9] offset:-1792 nt
  global_load_dwordx4 v[208:211], v98, s[8:9] offset:0 nt
  global_load_dwordx4 v[212:215], v98, s[8:9] offset:256 nt
  global_load_dwordx4 v[216:219], v98, s[8:9] offset:2048 nt
  global_load_dwordx4 v[220:223], v98, s[8:9] offset:2304 nt
  global_load_dwordx4 v[224:227], v99, s[8:9] offset:-4096 nt
  global_load_dwordx4 v[228:231], v99, s[8:9] offset:-3840 nt
  global_load_dwordx4 v[232:235], v99, s[8:9] offset:-2048 nt
  global_load_dwordx4 v[236:239], v99, s[8:9] offset:-1792 nt
  global_load_dwordx4 v[240:243], v99, s[8:9] offset:0 nt
  global_load_dwordx4 v[244:247], v99, s[8:9] offset:256 nt
  global_load_dwordx4 v[248:251], v99, s[8:9] offset:2048 nt
  global_load_dwordx4 v[252:255], v99, s[8:9] offset:2304 nt
  v_mov_b32 v90, 70784
  s_cmp_ge_u32 s30, 4
  s_cbranch_scc1 L_notrig
  s_mov_b32 s32, 0
  s_mov_b32 s33, 0
  s_mov_b32 s66, 0
  s_cmp_lt_u32 s29, 28
  s_cselect_b32 s67, s30, 0
  s_cmp_ge_u32 s29, 14
  s_cselect_b32 s37, 1, 0
  s_mul_i32 s49, s37, 14
  s_sub_u32 s38, s29, s49
  s_mov_b32 s60, 0x3db8aa3b
  s_lshr_b32 s36, s34, 2
  s_xor_b32 s36, s36, 0
  s_lshl_b32 s36, s36, 13
  s_mov_b64 s[40:41], s[26:27]
  s_add_u32 s44, s26, 16384
  s_addc_u32 s45, s27, 0
  s_add_u32 s42, s26, 16384
  s_addc_u32 s43, s27, 0
  v_and_b32 v102, 15, v0
  v_lshrrev_b32 v103, 4, v0
  v_and_b32 v100, 1, v102
  v_lshlrev_b32 v100, 4, v100
  v_mov_b32 v101, 0xffff
  v_lshlrev_b32 v101, v100, v101
  v_bfe_u32 v100, v102, 1, 2
  v_cmp_eq_u32 vcc, 0, v100
  s_nop 1
  v_cndmask_b32 v4, 0, v101, vcc
  v_cmp_eq_u32 vcc, 1, v100
  s_nop 1
  v_cndmask_b32 v5, 0, v101, vcc
  v_cmp_eq_u32 vcc, 2, v100
  s_nop 1
  v_cndmask_b32 v6, 0, v101, vcc
  v_cmp_eq_u32 vcc, 3, v100
  s_nop 1
  v_cndmask_b32 v7, 0, v101, vcc
  v_lshrrev_b32 v100, 3, v102
  v_lshlrev_b32 v8, 9, v100
  v_bfe_u32 v101, v102, 2, 1
  v_lshl_add_u32 v8, v101, 10, v8
  v_lshl_add_u32 v8, v103, 4, v8
  v_add_u32 v8, 52224, v8
  v_lshrrev_b32 v101, 1, v103
  v_lshlrev_b32 v9, 10, v101
  v_lshl_add_u32 v9, v102, 5, v9
  v_and_b32 v101, 1, v103
  v_lshl_add_u32 v9, v101, 4, v9
  s_lshl_b32 s49, s30, 11
  s_add_u32 s49, s49, 54272
  v_add_u32 v9, s49, v9
  s_lshl_b32 s49, s30, 3
  s_add_u32 s49, s49, 70656
  v_lshlrev_b32 v10, 6, v100
  v_add_u32 v10, s49, v10
  v_mov_b32 v90, 70784
  s_cmp_eq_u32 s30, 3
  s_cbranch_scc0 L_notrig
  v_mov_b32 v91, 1
  s_waitcnt vmcnt(0)
  ds_write_b32 v90, v91 offset:8
L_notrig:
  s_waitcnt vmcnt(32) lgkmcnt(0)
  s_barrier
  ds_read_b32 v92, v90
  s_waitcnt lgkmcnt(0)
  v_readfirstlane_b32 s31, v92
  s_cmp_eq_u32 s31, 0
  s_cselect_b32 s39, s28, s34
  s_lshr_b32 s35, s39, 2
  s_xor_b32 s35, s35, 0
  s_lshl_b32 s35, s35, 13
  s_and_b32 s39, s39, 3
  s_mul_i32 s65, s39, 49152
  s_add_u32 s65, s65, s35
  s_add_u32 s65, s65, 393216
  v_and_b32 v102, 15, v0
  v_lshrrev_b32 v103, 4, v0
  v_lshrrev_b32 v100, 2, v102
  v_lshl_add_u32 v100, v103, 3, v100
  v_and_b32 v101, 3, v102
  v_lshlrev_b32 v1, 6, v100
  v_lshl_add_u32 v1, v101, 3, v1
  s_lshl_b32 s50, s39, 1
  s_add_u32 s50, s50, s37
  s_lshl_b32 s50, s50, 1
  s_add_u32 s50, s50, s30
  s_lshl_b32 s50, s50, 14
  s_add_u32 s50, s50, s35
  s_add_u32 s50, s50, 135168
  v_lshlrev_b32 v13, 4, v0
  v_add_u32 v13, s50, v13
  s_lshl_b32 s49, s37, 8
  s_lshl_b32 s50, s30, 7
  s_add_u32 s49, s49, s50
  s_add_u32 s49, s49, s65
  s_add_u32 s49, s49, 7168
  v_lshlrev_b32 v14, 3, v102
  v_add_u32 v14, s49, v14
  s_lshl_b32 s49, s38, 15
  s_lshl_b32 s50, s28, 1
  s_add_u32 s50, s50, s37
  s_lshl_b32 s50, s50, 9
  s_add_u32 s49, s49, s50
  s_lshl_b32 s50, s30, 8
  s_add_u32 s49, s49, s50
  s_add_u32 s49, s49, 589824
  v_and_b32 v100, 1, v102
  v_lshlrev_b32 v15, 14, v100
  v_bfe_u32 v100, v102, 1, 1
  v_lshl_add_u32 v15, v100, 13, v15
  v_lshrrev_b32 v100, 2, v102
  v_lshl_add_u32 v15, v100, 6, v15
  v_lshl_add_u32 v15, v103, 4, v15
  v_add_u32 v15, s49, v15
  s_lshl_b32 s49, s29, 14
  s_add_u32 s49, s49, s36
  s_add_u32 s49, s49, 593920
  v_lshlrev_b32 v12, 4, v0
  v_add_u32 v12, s49, v12
  s_mov_b32 s58, 0xaaaaaaaa
  s_mov_b32 s59, 0xaaaaaaaa
  s_and_b32 s48, s30, 3
  s_lshl_b32 s49, s48, 9
  s_add_u32 s49, s49, 54272
  v_lshlrev_b32 v16, 3, v0
  v_add_u32 v16, s49, v16
  s_lshr_b32 s48, s48, 1
  s_lshl_b32 s49, s48, 6
  s_add_u32 s49, s49, 70656
  v_mov_b32 v17, s49
  s_lshl_b32 s50, s39, 1
  s_add_u32 s50, s50, s48
  s_lshl_b32 s50, s50, 1
  s_lshr_b32 s51, s29, 4
  s_add_u32 s50, s50, s51
  s_lshl_b32 s50, s50, 14
  s_add_u32 s50, s50, s35
  s_and_b32 s51, s29, 15
  s_lshl_b32 s51, s51, 4
  s_add_u32 s50, s50, s51
  s_and_b32 s51, s30, 1
  s_lshl_b32 s51, s51, 12
  s_add_u32 s50, s50, s51
  s_add_u32 s50, s50, 131072
  v_lshrrev_b32 v18, 2, v0
  v_lshlrev_b32 v18, 8, v18
  v_and_b32 v19, 3, v0
  v_lshl_add_u32 v18, v19, 2, v18
  v_add_u32 v18, s50, v18
  s_lshl_b32 s49, s48, 8
  s_lshl_b32 s51, s29, 3
  s_add_u32 s49, s49, s51
  s_add_u32 s49, s49, s65
  s_add_u32 s49, s49, 7168
  v_mov_b32 v19, s49
  v_mov_b32 v20, 0
  v_mov_b32 v21, 0
  v_mov_b32 v22, 0
  v_mov_b32 v23, 0
  v_mov_b32 v24, 0
  v_mov_b32 v25, 0
  v_mov_b32 v26, 0
  v_mov_b32 v27, 0
  v_mov_b32 v28, 0
  v_mov_b32 v29, 0
  ds_read_b128 v[32:35], v8 offset:0
  ds_read_b128 v[36:39], v8 offset:64
  ds_read_b128 v[40:43], v8 offset:128
  ds_read_b128 v[44:47], v8 offset:192
  ds_read_b128 v[48:51], v8 offset:256
  ds_read_b128 v[52:55], v8 offset:320
  ds_read_b128 v[56:59], v8 offset:384
  ds_read_b128 v[60:63], v8 offset:448
  s_waitcnt vmcnt(24)
  s_waitcnt lgkmcnt(7)
  v_mfma_f32_16x16x32_bf16 v[64:67], v[128:131], v[32:35], 0
  s_waitcnt lgkmcnt(6)
  v_mfma_f32_16x16x32_bf16 v[64:67], v[132:135], v[36:39], v[64:67]
  s_waitcnt lgkmcnt(5)
  v_mfma_f32_16x16x32_bf16 v[64:67], v[136:139], v[40:43], v[64:67]
  s_waitcnt lgkmcnt(4)
  v_mfma_f32_16x16x32_bf16 v[64:67], v[140:143], v[44:47], v[64:67]
  s_waitcnt lgkmcnt(3)
  v_mfma_f32_16x16x32_bf16 v[64:67], v[144:147], v[48:51], v[64:67]
  s_waitcnt lgkmcnt(2)
  v_mfma_f32_16x16x32_bf16 v[64:67], v[148:151], v[52:55], v[64:67]
  s_waitcnt lgkmcnt(1)
  v_mfma_f32_16x16x32_bf16 v[64:67], v[152:155], v[56:59], v[64:67]
  s_waitcnt lgkmcnt(0)
  v_mfma_f32_16x16x32_bf16 v[64:67], v[156:159], v[60:63], v[64:67]
  s_waitcnt vmcnt(16)
  v_mfma_f32_16x16x32_bf16 v[68:71], v[160:163], v[32:35], 0
  v_mfma_f32_16x16x32_bf16 v[68:71], v[164:167], v[36:39], v[68:71]
  v_mfma_f32_16x16x32_bf16 v[68:71], v[168:171], v[40:43], v[68:71]
  v_mfma_f32_16x16x32_bf16 v[68:71], v[172:175], v[44:47], v[68:71]
  v_mfma_f32_16x16x32_bf16 v[68:71], v[176:179], v[48:51], v[68:71]
  v_mfma_f32_16x16x32_bf16 v[68:71], v[180:183], v[52:55], v[68:71]
  v_mfma_f32_16x16x32_bf16 v[68:71], v[184:187], v[56:59], v[68:71]
  v_mfma_f32_16x16x32_bf16 v[68:71], v[188:191], v[60:63], v[68:71]
  v_add_f32_dpp v64, v64, v64 row_half_mirror row_mask:0xf bank_mask:0xf
  v_add_f32_dpp v65, v65, v65 row_half_mirror row_mask:0xf bank_mask:0xf
  v_add_f32_dpp v66, v66, v66 row_half_mirror row_mask:0xf bank_mask:0xf
  v_add_f32_dpp v67, v67, v67 row_half_mirror row_mask:0xf bank_mask:0xf
  s_nop 3
  v_add_f32_dpp v68, v68, v68 row_half_mirror row_mask:0xf bank_mask:0xf
  v_add_f32_dpp v69, v69, v69 row_half_mirror row_mask:0xf bank_mask:0xf
  v_add_f32_dpp v70, v70, v70 row_half_mirror row_mask:0xf bank_mask:0xf
  v_add_f32_dpp v71, v71, v71 row_half_mirror row_mask:0xf bank_mask:0xf
  v_max3_f32 v88, v64, v65, v66
  v_max3_f32 v88, v67, v68, v88
  v_max3_f32 v88, v69, v70, v88
  v_max_f32 v88, v71, v88
  v_mov_b32 v90, v88
  s_nop 1
  v_permlane32_swap_b32 v88, v90
  v_max_f32 v88, v88, v90
  v_mov_b32 v90, v88
  s_nop 1
  v_permlane16_swap_b32 v88, v90
  v_max_f32 v88, v88, v90
  v_mul_f32 v88, s60, v88
  v_fma_f32 v64, v64, s60, -v88
  v_fma_f32 v65, v65, s60, -v88
  v_fma_f32 v66, v66, s60, -v88
  v_fma_f32 v67, v67, s60, -v88
  v_fma_f32 v68, v68, s60, -v88
  v_fma_f32 v69, v69, s60, -v88
  v_fma_f32 v70, v70, s60, -v88
  v_fma_f32 v71, v71, s60, -v88
  v_exp_f32 v64, v64
  v_exp_f32 v65, v65
  v_exp_f32 v66, v66
  v_exp_f32 v67, v67
  v_exp_f32 v68, v68
  v_exp_f32 v69, v69
  v_exp_f32 v70, v70
  v_exp_f32 v71, v71
  v_cvt_pk_bf16_f32 v91, v64, v64
  v_and_b32 v72, v91, v4
  v_and_b32 v73, v91, v5
  v_and_b32 v74, v91, v6
  v_and_b32 v75, v91, v7
  s_waitcnt vmcnt(14)
  s_nop 0
  v_mfma_f32_16x16x32_bf16 v[80:83], v[72:75], v[192:195], 0
  v_mfma_f32_16x16x32_bf16 v[84:87], v[72:75], v[196:199], 0
  v_cvt_pk_bf16_f32 v91, v65, v65
  v_and_b32 v76, v91, v4
  v_and_b32 v77, v91, v5
  v_and_b32 v78, v91, v6
  v_and_b32 v79, v91, v7
  v_add_f32 v89, v64, v65
  s_waitcnt vmcnt(12)
  v_mfma_f32_16x16x32_bf16 v[80:83], v[76:79], v[200:203], v[80:83]
  v_mfma_f32_16x16x32_bf16 v[84:87], v[76:79], v[204:207], v[84:87]
  v_cvt_pk_bf16_f32 v91, v66, v66
  v_and_b32 v72, v91, v4
  v_and_b32 v73, v91, v5
  v_and_b32 v74, v91, v6
  v_and_b32 v75, v91, v7
  v_add_f32 v89, v89, v66
  s_waitcnt vmcnt(10)
  v_mfma_f32_16x16x32_bf16 v[80:83], v[72:75], v[208:211], v[80:83]
  v_mfma_f32_16x16x32_bf16 v[84:87], v[72:75], v[212:215], v[84:87]
  v_cvt_pk_bf16_f32 v91, v67, v67
  v_and_b32 v76, v91, v4
  v_and_b32 v77, v91, v5
  v_and_b32 v78, v91, v6
  v_and_b32 v79, v91, v7
  v_add_f32 v89, v89, v67
  s_waitcnt vmcnt(8)
  v_mfma_f32_16x16x32_bf16 v[80:83], v[76:79], v[216:219], v[80:83]
  v_mfma_f32_16x16x32_bf16 v[84:87], v[76:79], v[220:223], v[84:87]
  v_cvt_pk_bf16_f32 v91, v68, v68
  v_and_b32 v72, v91, v4
  v_and_b32 v73, v91, v5
  v_and_b32 v74, v91, v6
  v_and_b32 v75, v91, v7
  v_add_f32 v89, v89, v68
  s_waitcnt vmcnt(6)
  v_mfma_f32_16x16x32_bf16 v[80:83], v[72:75], v[224:227], v[80:83]
  v_mfma_f32_16x16x32_bf16 v[84:87], v[72:75], v[228:231], v[84:87]
  v_cvt_pk_bf16_f32 v91, v69, v69
  v_and_b32 v76, v91, v4
  v_and_b32 v77, v91, v5
  v_and_b32 v78, v91, v6
  v_and_b32 v79, v91, v7
  v_add_f32 v89, v89, v69
  s_waitcnt vmcnt(4)
  v_mfma_f32_16x16x32_bf16 v[80:83], v[76:79], v[232:235], v[80:83]
  v_mfma_f32_16x16x32_bf16 v[84:87], v[76:79], v[236:239], v[84:87]
  v_cvt_pk_bf16_f32 v91, v70, v70
  v_and_b32 v72, v91, v4
  v_and_b32 v73, v91, v5
  v_and_b32 v74, v91, v6
  v_and_b32 v75, v91, v7
  v_add_f32 v89, v89, v70
  s_waitcnt vmcnt(2)
  v_mfma_f32_16x16x32_bf16 v[80:83], v[72:75], v[240:243], v[80:83]
  v_mfma_f32_16x16x32_bf16 v[84:87], v[72:75], v[244:247], v[84:87]
  v_cvt_pk_bf16_f32 v91, v71, v71
  v_and_b32 v76, v91, v4
  v_and_b32 v77, v91, v5
  v_and_b32 v78, v91, v6
  v_and_b32 v79, v91, v7
  v_add_f32 v89, v89, v71
  s_waitcnt vmcnt(0)
  v_mfma_f32_16x16x32_bf16 v[80:83], v[76:79], v[248:251], v[80:83]
  v_mfma_f32_16x16x32_bf16 v[84:87], v[76:79], v[252:255], v[84:87]
  v_mov_b32 v90, v89
  s_nop 1
  v_permlane32_swap_b32 v89, v90
  v_add_f32 v89, v89, v90
  v_mov_b32 v90, v89
  s_nop 1
  v_permlane16_swap_b32 v89, v90
  v_add_f32 v89, v89, v90
  s_mov_b64 exec, 0x101
  ds_write_b64 v10, v[88:89]
  s_mov_b64 exec, -1
  ds_write_b128 v9, v[80:83]
  ds_write_b128 v9, v[84:87] offset:512
  s_branch L_attn_tail
L_attn:
  s_barrier
L_attn2:
  ds_read_b128 v[32:35], v8 offset:0
  ds_read_b128 v[36:39], v8 offset:64
  ds_read_b128 v[40:43], v8 offset:128
  ds_read_b128 v[44:47], v8 offset:192
  ds_read_b128 v[48:51], v8 offset:256
  ds_read_b128 v[52:55], v8 offset:320
  ds_read_b128 v[56:59], v8 offset:384
  ds_read_b128 v[60:63], v8 offset:448
  s_waitcnt lgkmcnt(7)
  v_mfma_f32_16x16x32_bf16 v[64:67], v[128:131], v[32:35], 0
  s_waitcnt lgkmcnt(6)
  v_mfma_f32_16x16x32_bf16 v[64:67], v[132:135], v[36:39], v[64:67]
  s_waitcnt lgkmcnt(5)
  v_mfma_f32_16x16x32_bf16 v[64:67], v[136:139], v[40:43], v[64:67]
  s_waitcnt lgkmcnt(4)
  v_mfma_f32_16x16x32_bf16 v[64:67], v[140:143], v[44:47], v[64:67]
  s_waitcnt lgkmcnt(3)
  v_mfma_f32_16x16x32_bf16 v[64:67], v[144:147], v[48:51], v[64:67]
  s_waitcnt lgkmcnt(2)
  v_mfma_f32_16x16x32_bf16 v[64:67], v[148:151], v[52:55], v[64:67]
  s_waitcnt lgkmcnt(1)
  v_mfma_f32_16x16x32_bf16 v[64:67], v[152:155], v[56:59], v[64:67]
  s_waitcnt lgkmcnt(0)
  v_mfma_f32_16x16x32_bf16 v[64:67], v[156:159], v[60:63], v[64:67]
  v_mfma_f32_16x16x32_bf16 v[68:71], v[160:163], v[32:35], 0
  v_mfma_f32_16x16x32_bf16 v[68:71], v[164:167], v[36:39], v[68:71]
  v_mfma_f32_16x16x32_bf16 v[68:71], v[168:171], v[40:43], v[68:71]
  v_mfma_f32_16x16x32_bf16 v[68:71], v[172:175], v[44:47], v[68:71]
  v_mfma_f32_16x16x32_bf16 v[68:71], v[176:179], v[48:51], v[68:71]
  v_mfma_f32_16x16x32_bf16 v[68:71], v[180:183], v[52:55], v[68:71]
  v_mfma_f32_16x16x32_bf16 v[68:71], v[184:187], v[56:59], v[68:71]
  v_mfma_f32_16x16x32_bf16 v[68:71], v[188:191], v[60:63], v[68:71]
  v_add_f32_dpp v64, v64, v64 row_half_mirror row_mask:0xf bank_mask:0xf
  v_add_f32_dpp v65, v65, v65 row_half_mirror row_mask:0xf bank_mask:0xf
  v_add_f32_dpp v66, v66, v66 row_half_mirror row_mask:0xf bank_mask:0xf
  v_add_f32_dpp v67, v67, v67 row_half_mirror row_mask:0xf bank_mask:0xf
  s_nop 3
  v_add_f32_dpp v68, v68, v68 row_half_mirror row_mask:0xf bank_mask:0xf
  v_add_f32_dpp v69, v69, v69 row_half_mirror row_mask:0xf bank_mask:0xf
  v_add_f32_dpp v70, v70, v70 row_half_mirror row_mask:0xf bank_mask:0xf
  v_add_f32_dpp v71, v71, v71 row_half_mirror row_mask:0xf bank_mask:0xf
  v_max3_f32 v88, v64, v65, v66
  v_max3_f32 v88, v67, v68, v88
  v_max3_f32 v88, v69, v70, v88
  v_max_f32 v88, v71, v88
  v_mov_b32 v90, v88
  s_nop 1
  v_permlane32_swap_b32 v88, v90
  v_max_f32 v88, v88, v90
  v_mov_b32 v90, v88
  s_nop 1
  v_permlane16_swap_b32 v88, v90
  v_max_f32 v88, v88, v90
  v_mul_f32 v88, s60, v88
  v_fma_f32 v64, v64, s60, -v88
  v_fma_f32 v65, v65, s60, -v88
  v_fma_f32 v66, v66, s60, -v88
  v_fma_f32 v67, v67, s60, -v88
  v_fma_f32 v68, v68, s60, -v88
  v_fma_f32 v69, v69, s60, -v88
  v_fma_f32 v70, v70, s60, -v88
  v_fma_f32 v71, v71, s60, -v88
  v_exp_f32 v64, v64
  v_exp_f32 v65, v65
  v_exp_f32 v66, v66
  v_exp_f32 v67, v67
  v_exp_f32 v68, v68
  v_exp_f32 v69, v69
  v_exp_f32 v70, v70
  v_exp_f32 v71, v71
  v_cvt_pk_bf16_f32 v91, v64, v64
  v_and_b32 v72, v91, v4
  v_and_b32 v73, v91, v5
  v_and_b32 v74, v91, v6
  v_and_b32 v75, v91, v7
  s_nop 1
  v_mfma_f32_16x16x32_bf16 v[80:83], v[72:75], v[192:195], 0
  v_mfma_f32_16x16x32_bf16 v[84:87], v[72:75], v[196:199], 0
  v_cvt_pk_bf16_f32 v91, v65, v65
  v_and_b32 v76, v91, v4
  v_and_b32 v77, v91, v5
  v_and_b32 v78, v91, v6
  v_and_b32 v79, v91, v7
  v_add_f32 v89, v64, v65
  s_nop 0
  v_mfma_f32_16x16x32_bf16 v[80:83], v[76:79], v[200:203], v[80:83]
  v_mfma_f32_16x16x32_bf16 v[84:87], v[76:79], v[204:207], v[84:87]
  v_cvt_pk_bf16_f32 v91, v66, v66
  v_and_b32 v72, v91, v4
  v_and_b32 v73, v91, v5
  v_and_b32 v74, v91, v6
  v_and_b32 v75, v91, v7
  v_add_f32 v89, v89, v66
  s_nop 0
  v_mfma_f32_16x16x32_bf16 v[80:83], v[72:75], v[208:211], v[80:83]
  v_mfma_f32_16x16x32_bf16 v[84:87], v[72:75], v[212:215], v[84:87]
  v_cvt_pk_bf16_f32 v91, v67, v67
  v_and_b32 v76, v91, v4
  v_and_b32 v77, v91, v5
  v_and_b32 v78, v91, v6
  v_and_b32 v79, v91, v7
  v_add_f32 v89, v89, v67
  s_nop 0
  v_mfma_f32_16x16x32_bf16 v[80:83], v[76:79], v[216:219], v[80:83]
  v_mfma_f32_16x16x32_bf16 v[84:87], v[76:79], v[220:223], v[84:87]
  v_cvt_pk_bf16_f32 v91, v68, v68
  v_and_b32 v72, v91, v4
  v_and_b32 v73, v91, v5
  v_and_b32 v74, v91, v6
  v_and_b32 v75, v91, v7
  v_add_f32 v89, v89, v68
  s_nop 0
  v_mfma_f32_16x16x32_bf16 v[80:83], v[72:75], v[224:227], v[80:83]
  v_mfma_f32_16x16x32_bf16 v[84:87], v[72:75], v[228:231], v[84:87]
  v_cvt_pk_bf16_f32 v91, v69, v69
  v_and_b32 v76, v91, v4
  v_and_b32 v77, v91, v5
  v_and_b32 v78, v91, v6
  v_and_b32 v79, v91, v7
  v_add_f32 v89, v89, v69
  s_nop 0
  v_mfma_f32_16x16x32_bf16 v[80:83], v[76:79], v[232:235], v[80:83]
  v_mfma_f32_16x16x32_bf16 v[84:87], v[76:79], v[236:239], v[84:87]
  v_cvt_pk_bf16_f32 v91, v70, v70
  v_and_b32 v72, v91, v4
  v_and_b32 v73, v91, v5
  v_and_b32 v74, v91, v6
  v_and_b32 v75, v91, v7
  v_add_f32 v89, v89, v70
  s_nop 0
  v_mfma_f32_16x16x32_bf16 v[80:83], v[72:75], v[240:243], v[80:83]
  v_mfma_f32_16x16x32_bf16 v[84:87], v[72:75], v[244:247], v[84:87]
  v_cvt_pk_bf16_f32 v91, v71, v71
  v_and_b32 v76, v91, v4
  v_and_b32 v77, v91, v5
  v_and_b32 v78, v91, v6
  v_and_b32 v79, v91, v7
  v_add_f32 v89, v89, v71
  s_nop 0
  v_mfma_f32_16x16x32_bf16 v[80:83], v[76:79], v[248:251], v[80:83]
  v_mfma_f32_16x16x32_bf16 v[84:87], v[76:79], v[252:255], v[84:87]
  v_mov_b32 v90, v89
  s_nop 1
  v_permlane32_swap_b32 v89, v90
  v_add_f32 v89, v89, v90
  v_mov_b32 v90, v89
  s_nop 1
  v_permlane16_swap_b32 v89, v90
  v_add_f32 v89, v89, v90
  s_mov_b64 exec, 0x101
  ds_write_b64 v10, v[88:89]
  s_mov_b64 exec, -1
  ds_write_b128 v9, v[80:83]
  ds_write_b128 v9, v[84:87] offset:512
L_attn_tail:
  s_cmp_lt_u32 s30, 4
  s_waitcnt lgkmcnt(0)
  s_barrier
  s_cbranch_scc1 L_lo
  ds_read_b128 v[32:35], v17 offset:0
  ds_read_b128 v[36:39], v17 offset:16
  ds_read_b128 v[40:43], v17 offset:32
  ds_read_b128 v[44:47], v17 offset:48
  ds_read_b64 v[48:49], v16 offset:0
  ds_read_b64 v[50:51], v16 offset:2048
  ds_read_b64 v[52:53], v16 offset:4096
  ds_read_b64 v[54:55], v16 offset:6144
  ds_read_b64 v[56:57], v16 offset:8192
  ds_read_b64 v[58:59], v16 offset:10240
  ds_read_b64 v[60:61], v16 offset:12288
  ds_read_b64 v[62:63], v16 offset:14336
  s_cmp_eq_u32 s31, 0
  s_waitcnt lgkmcnt(8)
  v_max3_f32 v88, v32, v34, v36
  v_max3_f32 v90, v38, v40, v42
  v_max3_f32 v88, v44, v46, v88
  v_max_f32 v88, v90, v88
  v_sub_f32 v32, v32, v88
  v_sub_f32 v34, v34, v88
  v_sub_f32 v36, v36, v88
  v_sub_f32 v38, v38, v88
  v_sub_f32 v40, v40, v88
  v_sub_f32 v42, v42, v88
  v_sub_f32 v44, v44, v88
  v_sub_f32 v46, v46, v88
  v_exp_f32 v32, v32
  v_exp_f32 v34, v34
  v_exp_f32 v36, v36
  v_exp_f32 v38, v38
  v_exp_f32 v40, v40
  v_exp_f32 v42, v42
  v_exp_f32 v44, v44
  v_exp_f32 v46, v46
  s_waitcnt lgkmcnt(0)
  v_pk_mul_f32 v[92:93], v[48:49], v[32:33] op_sel_hi:[1,0]
  v_pk_fma_f32 v[92:93], v[50:51], v[34:35], v[92:93] op_sel_hi:[1,0,1]
  v_pk_fma_f32 v[92:93], v[52:53], v[36:37], v[92:93] op_sel_hi:[1,0,1]
  v_pk_fma_f32 v[92:93], v[54:55], v[38:39], v[92:93] op_sel_hi:[1,0,1]
  v_pk_fma_f32 v[92:93], v[56:57], v[40:41], v[92:93] op_sel_hi:[1,0,1]
  v_pk_fma_f32 v[92:93], v[58:59], v[42:43], v[92:93] op_sel_hi:[1,0,1]
  v_pk_fma_f32 v[92:93], v[60:61], v[44:45], v[92:93] op_sel_hi:[1,0,1]
  v_pk_fma_f32 v[92:93], v[62:63], v[46:47], v[92:93] op_sel_hi:[1,0,1]
  v_cvt_pk_bf16_f32 v92, v92, v93
  v_min_u32 v92, -2, v92
  s_cbranch_scc1 SLOW_1
  global_store_dword v18, v92, s[40:41]
BACK_2:
  v_mul_f32 v89, v32, v33
  v_fmac_f32 v89, v34, v35
  v_fmac_f32 v89, v36, v37
  v_fmac_f32 v89, v38, v39
  v_fmac_f32 v89, v40, v41
  v_fmac_f32 v89, v42, v43
  v_fmac_f32 v89, v44, v45
  v_fmac_f32 v89, v46, v47
  s_cbranch_scc1 SLOW_3
  s_mov_b64 exec, 1
  global_store_dwordx2 v19, v[88:89], s[40:41]
  s_mov_b64 exec, -1
BACK_4:
L_bar3:
  s_barrier
L_next:
  s_cmp_eq_u32 s32, 1
  s_cbranch_scc1 L_exit
  s_cmp_lt_u32 s29, 28
  s_cbranch_scc0 L_bar4
  s_cmp_ge_u32 s30, 4
  s_cbranch_scc1 L_cal
  s_cmp_eq_u32 s30, 2
  s_cbranch_scc1 L_gather
  s_cmp_eq_u32 s30, 1
  s_cbranch_scc1 L_bar4w
  s_cmp_eq_u32 s30, 3
  s_cbranch_scc0 L_bar4
  s_mul_i32 s49, s2, 6144
  s_add_u32 s49, s49, 4197376
  v_lshlrev_b32 v108, 4, v0
  v_add_u32 v108, s49, v108
  v_mov_b32 v112, -1
  v_mov_b32 v113, -1
  v_mov_b32 v114, -1
  v_mov_b32 v115, -1
  global_store_dwordx4 v108, v[112:115], s[26:27] offset:-3072 sc1
  global_store_dwordx4 v108, v[112:115], s[26:27] offset:-2048 sc1
  global_store_dwordx4 v108, v[112:115], s[26:27] offset:-1024 sc1
  global_store_dwordx4 v108, v[112:115], s[26:27] offset:0 sc1
  global_store_dwordx4 v108, v[112:115], s[26:27] offset:1024 sc1
  global_store_dwordx4 v108, v[112:115], s[26:27] offset:2048 sc1
L_bar4w:
  s_waitcnt vmcnt(0)
L_bar4:
  s_barrier
L_bar4x:
  s_mov_b32 s32, 1
  v_mov_b32 v100, 70784
  ds_read_b64 v[100:101], v100 offset:16
  s_waitcnt lgkmcnt(0)
  v_cmp_lt_u32 vcc, v101, v100
  s_cmp_eq_u64 vcc, 0
  s_cselect_b32 s66, 0, 8192
  s_cmp_eq_u32 s66, s35
  s_cselect_b32 s66, 1, 0
  s_add_u32 s40, s26, 4194304
  s_addc_u32 s41, s27, 0
  s_branch L_attn
L_cal:
  s_lshr_b32 s48, s29, 2
  s_lshl_b32 s48, s48, 14
  s_and_b32 s49, s29, 3
  s_lshl_b32 s49, s49, 11
  s_add_u32 s48, s48, s49
  s_and_b32 s49, s30, 3
  s_lshl_b32 s49, s49, 9
  s_add_u32 s48, s48, s49
  s_add_u32 s48, s48, 4194304
  s_and_b32 s49, s30, 1
  s_lshl_b32 s51, s49, 13
  s_lshl_b32 s49, s49, 2
  s_add_u32 s50, s49, 70784
  v_mov_b32 v100, s50
  s_sub_u32 s50, 70788, s49
  v_mov_b32 v103, s50
  s_mov_b64 exec, 1
  s_add_u32 s49, s48, 0
  s_xor_b32 s49, s49, s51
  s_memtime s[52:53]
  s_waitcnt lgkmcnt(0)
  s_load_dword s50, s[26:27], s49
  s_waitcnt lgkmcnt(0)
  s_memtime s[54:55]
  s_waitcnt lgkmcnt(0)
  s_sub_u32 s50, s54, s52
  v_mov_b32 v101, s50
  s_add_u32 s49, s48, 8192
  s_xor_b32 s49, s49, s51
  s_memtime s[52:53]
  s_waitcnt lgkmcnt(0)
  s_load_dword s50, s[26:27], s49
  s_waitcnt lgkmcnt(0)
  s_memtime s[54:55]
  s_waitcnt lgkmcnt(0)
  s_sub_u32 s50, s54, s52
  v_mov_b32 v102, s50
  ds_min_u32 v100, v101 offset:16
  ds_min_u32 v103, v102 offset:16
  s_add_u32 s49, s48, 8320
  s_xor_b32 s49, s49, s51
  s_memtime s[52:53]
  s_waitcnt lgkmcnt(0)
  s_load_dword s50, s[26:27], s49
  s_waitcnt lgkmcnt(0)
  s_memtime s[54:55]
  s_waitcnt lgkmcnt(0)
  s_sub_u32 s50, s54, s52
  v_mov_b32 v102, s50
  s_add_u32 s49, s48, 128
  s_xor_b32 s49, s49, s51
  s_memtime s[52:53]
  s_waitcnt lgkmcnt(0)
  s_load_dword s50, s[26:27], s49
  s_waitcnt lgkmcnt(0)
  s_memtime s[54:55]
  s_waitcnt lgkmcnt(0)
  s_sub_u32 s50, s54, s52
  v_mov_b32 v101, s50
  ds_min_u32 v100, v101 offset:16
  ds_min_u32 v103, v102 offset:16
  s_barrier
  s_add_u32 s49, s48, 256
  s_xor_b32 s49, s49, s51
  s_memtime s[52:53]
  s_waitcnt lgkmcnt(0)
  s_load_dword s50, s[26:27], s49
  s_waitcnt lgkmcnt(0)
  s_memtime s[54:55]
  s_waitcnt lgkmcnt(0)
  s_sub_u32 s50, s54, s52
  v_mov_b32 v101, s50
  s_add_u32 s49, s48, 8448
  s_xor_b32 s49, s49, s51
  s_memtime s[52:53]
  s_waitcnt lgkmcnt(0)
  s_load_dword s50, s[26:27], s49
  s_waitcnt lgkmcnt(0)
  s_memtime s[54:55]
  s_waitcnt lgkmcnt(0)
  s_sub_u32 s50, s54, s52
  v_mov_b32 v102, s50
  ds_min_u32 v100, v101 offset:16
  ds_min_u32 v103, v102 offset:16
  s_mov_b64 exec, -1
  s_branch L_bar4x
L_gather:
  s_mul_i32 s49, s28, 448
  s_lshl_b32 s50, s29, 4
  s_add_u32 s49, s49, s50
  v_mul_u32_u24 v100, 3584, v0
  v_add_u32 v100, s49, v100
  v_mov_b32 v101, v100
  s_mul_i32 s49, s28, 200704
  s_lshl_b32 s50, s29, 5
  s_add_u32 s49, s49, s50
  v_lshrrev_b32 v102, 1, v0
  v_mul_u32_u24 v102, 896, v102
  v_and_b32 v103, 1, v0
  v_lshl_add_u32 v102, v103, 4, v102
  v_add_u32 v102, s49, v102
  v_mov_b32 v103, 70784
  s_waitcnt vmcnt(1)
  s_mov_b32 m0, 30720
  s_nop 0
  global_load_lds_dwordx4 v100, s[16:17] nt
  v_add_u32 v100, 229376, v100
  s_waitcnt vmcnt(1)
  s_mov_b32 m0, 31744
  s_nop 0
  global_load_lds_dwordx4 v100, s[16:17] nt
  v_add_u32 v100, 229376, v100
  s_barrier
  s_waitcnt vmcnt(1)
  ds_read_b32 v104, v103 offset:24
  s_waitcnt lgkmcnt(0)
  v_cmp_ne_u32 vcc, 0, v104
  s_mov_b32 s48, 2
  s_cbranch_vccnz L_gpause
  s_mov_b32 m0, 32768
  s_nop 0
  global_load_lds_dwordx4 v100, s[16:17] nt
  v_add_u32 v100, 229376, v100
  s_waitcnt vmcnt(1)
  ds_read_b32 v104, v103 offset:24
  s_waitcnt lgkmcnt(0)
  v_cmp_ne_u32 vcc, 0, v104
  s_mov_b32 s48, 3
  s_cbranch_vccnz L_gpause
  s_mov_b32 m0, 33792
  s_nop 0
  global_load_lds_dwordx4 v100, s[16:17] nt
  v_add_u32 v100, 229376, v100
  s_waitcnt vmcnt(1)
  ds_read_b32 v104, v103 offset:24
  s_waitcnt lgkmcnt(0)
  v_cmp_ne_u32 vcc, 0, v104
  s_mov_b32 s48, 4
  s_cbranch_vccnz L_gpause
  s_mov_b32 m0, 34816
  s_nop 0
  global_load_lds_dwordx4 v100, s[16:17] nt
  v_add_u32 v100, 229376, v100
  s_waitcnt vmcnt(1)
  ds_read_b32 v104, v103 offset:24
  s_waitcnt lgkmcnt(0)
  v_cmp_ne_u32 vcc, 0, v104
  s_mov_b32 s48, 5
  s_cbranch_vccnz L_gpause
  s_mov_b32 m0, 35840
  s_nop 0
  global_load_lds_dwordx4 v100, s[16:17] nt
  v_add_u32 v100, 229376, v100
  s_waitcnt vmcnt(1)
  ds_read_b32 v104, v103 offset:24
  s_waitcnt lgkmcnt(0)
  v_cmp_ne_u32 vcc, 0, v104
  s_mov_b32 s48, 6
  s_cbranch_vccnz L_gpause
  s_mov_b32 m0, 36864
  s_nop 0
  global_load_lds_dwordx4 v100, s[16:17] nt
  v_add_u32 v100, 229376, v100
  s_waitcnt vmcnt(1)
  ds_read_b32 v104, v103 offset:24
  s_waitcnt lgkmcnt(0)
  v_cmp_ne_u32 vcc, 0, v104
  s_mov_b32 s48, 7
  s_cbranch_vccnz L_gpause
  s_mov_b32 m0, 37888
  s_nop 0
  global_load_lds_dwordx4 v101, s[18:19] nt
  v_add_u32 v101, 229376, v101
  s_waitcnt vmcnt(1)
  ds_read_b32 v104, v103 offset:24
  s_waitcnt lgkmcnt(0)
  v_cmp_ne_u32 vcc, 0, v104
  s_mov_b32 s48, 8
  s_cbranch_vccnz L_gpause
  s_mov_b32 m0, 38912
  s_nop 0
  global_load_lds_dwordx4 v101, s[18:19] nt
  v_add_u32 v101, 229376, v101
  s_waitcnt vmcnt(1)
  ds_read_b32 v104, v103 offset:24
  s_waitcnt lgkmcnt(0)
  v_cmp_ne_u32 vcc, 0, v104
  s_mov_b32 s48, 9
  s_cbranch_vccnz L_gpause
  s_mov_b32 m0, 39936
  s_nop 0
  global_load_lds_dwordx4 v101, s[18:19] nt
  v_add_u32 v101, 229376, v101
  s_waitcnt vmcnt(1)
  ds_read_b32 v104, v103 offset:24
  s_waitcnt lgkmcnt(0)
  v_cmp_ne_u32 vcc, 0, v104
  s_mov_b32 s48, 10
  s_cbranch_vccnz L_gpause
  s_mov_b32 m0, 40960
  s_nop 0
  global_load_lds_dwordx4 v101, s[18:19] nt
  v_add_u32 v101, 229376, v101
  s_waitcnt vmcnt(1)
  ds_read_b32 v104, v103 offset:24
  s_waitcnt lgkmcnt(0)
  v_cmp_ne_u32 vcc, 0, v104
  s_mov_b32 s48, 11
  s_cbranch_vccnz L_gpause
  s_mov_b32 m0, 41984
  s_nop 0
  global_load_lds_dwordx4 v101, s[18:19] nt
  v_add_u32 v101, 229376, v101
  s_waitcnt vmcnt(1)
  ds_read_b32 v104, v103 offset:24
  s_waitcnt lgkmcnt(0)
  v_cmp_ne_u32 vcc, 0, v104
  s_mov_b32 s48, 12
  s_cbranch_vccnz L_gpause
  s_mov_b32 m0, 43008
  s_nop 0
  global_load_lds_dwordx4 v101, s[18:19] nt
  v_add_u32 v101, 229376, v101
  s_waitcnt vmcnt(1)
  ds_read_b32 v104, v103 offset:24
  s_waitcnt lgkmcnt(0)
  v_cmp_ne_u32 vcc, 0, v104
  s_mov_b32 s48, 13
  s_cbranch_vccnz L_gpause
  s_mov_b32 m0, 44032
  s_nop 0
  global_load_lds_dwordx4 v101, s[18:19] nt
  v_add_u32 v101, 229376, v101
  s_waitcnt vmcnt(1)
  ds_read_b32 v104, v103 offset:24
  s_waitcnt lgkmcnt(0)
  v_cmp_ne_u32 vcc, 0, v104
  s_mov_b32 s48, 14
  s_cbranch_vccnz L_gpause
  s_mov_b32 m0, 45056
  s_nop 0
  global_load_lds_dwordx4 v102, s[20:21] nt
  v_add_u32 v102, 28672, v102
  s_waitcnt vmcnt(1)
  ds_read_b32 v104, v103 offset:24
  s_waitcnt lgkmcnt(0)
  v_cmp_ne_u32 vcc, 0, v104
  s_mov_b32 s48, 15
  s_cbranch_vccnz L_gpause
  s_mov_b32 m0, 46080
  s_nop 0
  global_load_lds_dwordx4 v102, s[20:21] nt
  v_add_u32 v102, 28672, v102
  s_waitcnt vmcnt(1)
  ds_read_b32 v104, v103 offset:24
  s_waitcnt lgkmcnt(0)
  v_cmp_ne_u32 vcc, 0, v104
  s_mov_b32 s48, 16
  s_cbranch_vccnz L_gpause
  s_mov_b32 m0, 47104
  s_nop 0
  global_load_lds_dwordx4 v102, s[20:21] nt
  v_add_u32 v102, 28672, v102
  s_waitcnt vmcnt(1)
  ds_read_b32 v104, v103 offset:24
  s_waitcnt lgkmcnt(0)
  v_cmp_ne_u32 vcc, 0, v104
  s_mov_b32 s48, 17
  s_cbranch_vccnz L_gpause
  s_mov_b32 m0, 48128
  s_nop 0
  global_load_lds_dwordx4 v102, s[20:21] nt
  v_add_u32 v102, 28672, v102
  s_waitcnt vmcnt(1)
  ds_read_b32 v104, v103 offset:24
  s_waitcnt lgkmcnt(0)
  v_cmp_ne_u32 vcc, 0, v104
  s_mov_b32 s48, 18
  s_cbranch_vccnz L_gpause
  s_mov_b32 m0, 49152
  s_nop 0
  global_load_lds_dwordx4 v102, s[20:21] nt
  v_add_u32 v102, 28672, v102
  s_waitcnt vmcnt(1)
  ds_read_b32 v104, v103 offset:24
  s_waitcnt lgkmcnt(0)
  v_cmp_ne_u32 vcc, 0, v104
  s_mov_b32 s48, 19
  s_cbranch_vccnz L_gpause
  s_mov_b32 m0, 50176
  s_nop 0
  global_load_lds_dwordx4 v102, s[20:21] nt
  v_add_u32 v102, 28672, v102
  s_waitcnt vmcnt(1)
  ds_read_b32 v104, v103 offset:24
  s_waitcnt lgkmcnt(0)
  v_cmp_ne_u32 vcc, 0, v104
  s_mov_b32 s48, 20
  s_cbranch_vccnz L_gpause
  s_mov_b32 m0, 51200
  s_nop 0
  global_load_lds_dwordx4 v102, s[20:21] nt
  v_add_u32 v102, 28672, v102
  s_branch L_bar4w
L_gpause:
  ds_read_b32 v104, v103 offset:28
  s_add_u32 s33, s33, 1
  s_cmp_gt_u32 s33, 400000
  s_cbranch_scc1 L_exit
  s_waitcnt lgkmcnt(0)
  v_cmp_eq_u32 vcc, 0, v104
  s_cbranch_vccnz L_gpause
  s_cmp_gt_u32 s48, 0
  s_cbranch_scc1 L_gs0
  s_mov_b32 m0, 30720
  s_nop 0
  global_load_lds_dwordx4 v100, s[16:17] nt
  v_add_u32 v100, 229376, v100
L_gs0:
  s_cmp_gt_u32 s48, 1
  s_cbranch_scc1 L_gs1
  s_mov_b32 m0, 31744
  s_nop 0
  global_load_lds_dwordx4 v100, s[16:17] nt
  v_add_u32 v100, 229376, v100
L_gs1:
  s_cmp_gt_u32 s48, 2
  s_cbranch_scc1 L_gs2
  s_mov_b32 m0, 32768
  s_nop 0
  global_load_lds_dwordx4 v100, s[16:17] nt
  v_add_u32 v100, 229376, v100
L_gs2:
  s_cmp_gt_u32 s48, 3
  s_cbranch_scc1 L_gs3
  s_mov_b32 m0, 33792
  s_nop 0
  global_load_lds_dwordx4 v100, s[16:17] nt
  v_add_u32 v100, 229376, v100
L_gs3:
  s_cmp_gt_u32 s48, 4
  s_cbranch_scc1 L_gs4
  s_mov_b32 m0, 34816
  s_nop 0
  global_load_lds_dwordx4 v100, s[16:17] nt
  v_add_u32 v100, 229376, v100
L_gs4:
  s_cmp_gt_u32 s48, 5
  s_cbranch_scc1 L_gs5
  s_mov_b32 m0, 35840
  s_nop 0
  global_load_lds_dwordx4 v100, s[16:17] nt
  v_add_u32 v100, 229376, v100
L_gs5:
  s_cmp_gt_u32 s48, 6
  s_cbranch_scc1 L_gs6
  s_mov_b32 m0, 36864
  s_nop 0
  global_load_lds_dwordx4 v100, s[16:17] nt
  v_add_u32 v100, 229376, v100
L_gs6:
  s_cmp_gt_u32 s48, 7
  s_cbranch_scc1 L_gs7
  s_mov_b32 m0, 37888
  s_nop 0
  global_load_lds_dwordx4 v101, s[18:19] nt
  v_add_u32 v101, 229376, v101
L_gs7:
  s_cmp_gt_u32 s48, 8
  s_cbranch_scc1 L_gs8
  s_mov_b32 m0, 38912
  s_nop 0
  global_load_lds_dwordx4 v101, s[18:19] nt
  v_add_u32 v101, 229376, v101
L_gs8:
  s_cmp_gt_u32 s48, 9
  s_cbranch_scc1 L_gs9
  s_mov_b32 m0, 39936
  s_nop 0
  global_load_lds_dwordx4 v101, s[18:19] nt
  v_add_u32 v101, 229376, v101
L_gs9:
  s_cmp_gt_u32 s48, 10
  s_cbranch_scc1 L_gs10
  s_mov_b32 m0, 40960
  s_nop 0
  global_load_lds_dwordx4 v101, s[18:19] nt
  v_add_u32 v101, 229376, v101
L_gs10:
  s_cmp_gt_u32 s48, 11
  s_cbranch_scc1 L_gs11
  s_mov_b32 m0, 41984
  s_nop 0
  global_load_lds_dwordx4 v101, s[18:19] nt
  v_add_u32 v101, 229376, v101
L_gs11:
  s_cmp_gt_u32 s48, 12
  s_cbranch_scc1 L_gs12
  s_mov_b32 m0, 43008
  s_nop 0
  global_load_lds_dwordx4 v101, s[18:19] nt
  v_add_u32 v101, 229376, v101
L_gs12:
  s_cmp_gt_u32 s48, 13
  s_cbranch_scc1 L_gs13
  s_mov_b32 m0, 44032
  s_nop 0
  global_load_lds_dwordx4 v101, s[18:19] nt
  v_add_u32 v101, 229376, v101
L_gs13:
  s_cmp_gt_u32 s48, 14
  s_cbranch_scc1 L_gs14
  s_mov_b32 m0, 45056
  s_nop 0
  global_load_lds_dwordx4 v102, s[20:21] nt
  v_add_u32 v102, 28672, v102
L_gs14:
  s_cmp_gt_u32 s48, 15
  s_cbranch_scc1 L_gs15
  s_mov_b32 m0, 46080
  s_nop 0
  global_load_lds_dwordx4 v102, s[20:21] nt
  v_add_u32 v102, 28672, v102
L_gs15:
  s_cmp_gt_u32 s48, 16
  s_cbranch_scc1 L_gs16
  s_mov_b32 m0, 47104
  s_nop 0
  global_load_lds_dwordx4 v102, s[20:21] nt
  v_add_u32 v102, 28672, v102
L_gs16:
  s_cmp_gt_u32 s48, 17
  s_cbranch_scc1 L_gs17
  s_mov_b32 m0, 48128
  s_nop 0
  global_load_lds_dwordx4 v102, s[20:21] nt
  v_add_u32 v102, 28672, v102
L_gs17:
  s_cmp_gt_u32 s48, 18
  s_cbranch_scc1 L_gs18
  s_mov_b32 m0, 49152
  s_nop 0
  global_load_lds_dwordx4 v102, s[20:21] nt
  v_add_u32 v102, 28672, v102
L_gs18:
  s_cmp_gt_u32 s48, 19
  s_cbranch_scc1 L_gs19
  s_mov_b32 m0, 50176
  s_nop 0
  global_load_lds_dwordx4 v102, s[20:21] nt
  v_add_u32 v102, 28672, v102
L_gs19:
  s_cmp_gt_u32 s48, 20
  s_cbranch_scc1 L_gs20
  s_mov_b32 m0, 51200
  s_nop 0
  global_load_lds_dwordx4 v102, s[20:21] nt
  v_add_u32 v102, 28672, v102
L_gs20:
  s_branch L_bar4w
L_w23:
  s_cmp_eq_u32 s32, 0
  s_cbranch_scc0 L_bar3
  s_cmp_eq_u32 s30, 3
  s_cbranch_scc1 L_cc
  s_cmp_lt_u32 s29, 28
  s_cbranch_scc1 L_gather
  s_branch L_bar3
L_cc:
  v_and_b32 v100, 15, v0
  v_lshrrev_b32 v101, 4, v0
  v_lshrrev_b32 v106, 2, v100
  v_lshl_add_u32 v106, v101, 3, v106
  v_and_b32 v107, 3, v100
  v_lshlrev_b32 v28, 5, v106
  v_lshl_add_u32 v28, v107, 3, v28
  v_lshlrev_b32 v29, 4, v106
  v_and_b32 v106, 1, v107
  v_lshl_add_u32 v29, v106, 3, v29
  v_lshrrev_b32 v106, 1, v107
  v_mul_u32_u24 v106, 7168, v106
  v_add_u32 v29, v106, v29
  v_and_b32 v102, 7, v100
  v_lshrrev_b32 v103, 3, v100
  v_lshrrev_b32 v104, 1, v101
  v_and_b32 v105, 1, v101
  s_lshl_b32 s49, s29, 8
  s_add_u32 s49, s49, s65
  v_bfe_u32 v16, v0, 2, 3
  v_lshlrev_b32 v16, 4, v16
  v_bfe_u32 v106, v0, 1, 1
  v_lshl_add_u32 v16, v106, 7, v16
  v_and_b32 v106, 1, v0
  v_lshl_add_u32 v16, v106, 3, v16
  v_lshl_add_u32 v16, v104, 2, v16
  v_add_u32 v16, s49, v16
  s_add_u32 s48, s65, 32768
  s_lshr_b32 s49, s29, 2
  s_lshl_b32 s49, s49, 7
  s_add_u32 s49, s49, s48
  s_and_b32 s50, s29, 2
  s_lshl_b32 s50, s50, 9
  s_add_u32 s49, s49, s50
  s_and_b32 s50, s29, 1
  s_lshl_b32 s50, s50, 3
  s_add_u32 s49, s49, s50
  v_bfe_u32 v17, v0, 2, 3
  v_lshlrev_b32 v17, 4, v17
  v_lshl_add_u32 v17, v104, 2, v17
  v_add_u32 v17, s49, v17
  v_lshlrev_b32 v106, 8, v104
  v_lshl_add_u32 v106, v102, 4, v106
  v_lshl_add_u32 v106, v105, 7, v106
  v_add_u32 v106, s65, v106
  v_mul_u32_u24 v18, 3584, v103
  v_add_u32 v18, v18, v106
  v_mul_u32_u24 v27, 1536, v103
  v_add_u32 v27, v27, v106
  s_and_b32 s49, s29, 1
  s_mul_i32 s49, s49, 3584
  v_add_u32 v27, s49, v27
  v_lshlrev_b32 v19, 4, v0
  v_add_u32 v19, s48, v19
  s_add_u32 s48, s48, 4096
  s_lshl_b32 s49, s29, 7
  s_add_u32 s49, s49, s48
  v_lshlrev_b32 v20, 4, v102
  v_lshl_add_u32 v20, v105, 3, v20
  v_lshl_add_u32 v20, v104, 2, v20
  v_add_u32 v20, s49, v20
  v_mul_u32_u24 v21, 12, v103
  v_add_u32 v21, v21, v101
  v_lshlrev_b32 v21, 7, v21
  v_lshl_add_u32 v21, v102, 4, v21
  v_add_u32 v21, s48, v21
  s_lshr_b32 s49, s29, 1
  s_lshl_b32 s49, s49, 14
  s_and_b32 s50, s29, 1
  s_lshl_b32 s50, s50, 12
  s_add_u32 s49, s49, s50
  s_add_u32 s49, s49, 1048576
  s_lshl_b32 s50, s28, 9
  s_add_u32 s50, s50, s49
  v_lshlrev_b32 v22, 6, v102
  v_lshl_add_u32 v22, v101, 4, v22
  v_lshl_add_u32 v22, v103, 13, v22
  v_add_u32 v22, s50, v22
  s_add_u32 s49, s49, s36
  v_lshlrev_b32 v24, 4, v0
  v_add_u32 v24, s49, v24
  s_lshl_b32 s48, s39, 15
  s_add_u32 s48, s48, s35
  s_add_u32 s48, s48, 0
  s_and_b32 s49, s29, 1
  s_lshl_b32 s49, s49, 14
  s_lshr_b32 s50, s29, 1
  s_lshl_b32 s50, s50, 6
  s_add_u32 s49, s49, s50
  s_add_u32 s49, s49, s48
  v_lshlrev_b32 v25, 10, v102
  v_lshl_add_u32 v25, v103, 5, v25
  v_lshl_add_u32 v25, v101, 3, v25
  v_add_u32 v25, s49, v25
  s_lshr_b32 s49, s29, 2
  s_lshl_b32 s49, s49, 10
  s_add_u32 s49, s49, s48
  v_lshlrev_b32 v26, 4, v0
  v_add_u32 v26, s49, v26
  v_lshlrev_b32 v100, 4, v0
  v_add_u32 v100, 104448, v100
  ds_write_b128 v100, v[16:19] offset:0
  ds_write_b128 v100, v[20:23] offset:1024
  ds_write_b128 v100, v[24:27] offset:2048
  ds_write_b64 v100, v[28:29] offset:3072
  s_waitcnt lgkmcnt(0)
  s_branch L_bar3
L_lo:
  s_cmp_lt_u32 s30, 2
  s_cbranch_scc0 L_w23
  s_cmp_lt_u32 s29, 28
  s_cbranch_scc1 L_p3
  s_barrier
  s_cmp_eq_u32 s30, 1
  s_cbranch_scc1 L_next
  s_cmp_eq_u32 s32, 1
  s_cbranch_scc1 L_exit
  s_barrier
  v_lshlrev_b32 v2, 4, v0
  v_add_u32 v2, 104448, v2
  ds_read_b64 v[28:29], v2 offset:3072
  ds_read_b128 v[16:19], v2 offset:0
  ds_read_b128 v[20:23], v2 offset:1024
  ds_read_b128 v[24:27], v2 offset:2048
  v_mov_b32 v4, 0
  v_mov_b32 v5, 0
  v_mov_b32 v6, 0
  v_mov_b32 v7, 0
  v_mov_b32 v8, 0
  v_mov_b32 v9, 0
  v_mov_b32 v10, 0
  v_mov_b32 v11, 0
  s_waitcnt lgkmcnt(0)
  ds_read_b64_tr_b16 v[64:65], v1 offset:0
  ds_read_b64_tr_b16 v[66:67], v1 offset:256
  ds_read_b64_tr_b16 v[68:69], v1 offset:2048
  ds_read_b64_tr_b16 v[70:71], v1 offset:2304
  ds_read_b64_tr_b16 v[72:73], v1 offset:4096
  ds_read_b64_tr_b16 v[74:75], v1 offset:4352
  ds_read_b64_tr_b16 v[76:77], v1 offset:6144
  ds_read_b64_tr_b16 v[78:79], v1 offset:6400
  ds_read_b64_tr_b16 v[80:81], v1 offset:8192
  ds_read_b64_tr_b16 v[82:83], v1 offset:8448
  ds_read_b64_tr_b16 v[84:85], v1 offset:10240
  ds_read_b64_tr_b16 v[86:87], v1 offset:10496
  ds_read_b64_tr_b16 v[88:89], v1 offset:12288
  ds_read_b64_tr_b16 v[90:91], v1 offset:12544
  ds_read_b64_tr_b16 v[92:93], v1 offset:32
  ds_read_b64_tr_b16 v[94:95], v1 offset:288
  ds_read_b64_tr_b16 v[96:97], v1 offset:2080
  ds_read_b64_tr_b16 v[98:99], v1 offset:2336
  ds_read_b64_tr_b16 v[100:101], v1 offset:4128
  ds_read_b64_tr_b16 v[102:103], v1 offset:4384
  ds_read_b64_tr_b16 v[104:105], v1 offset:6176
  ds_read_b64_tr_b16 v[106:107], v1 offset:6432
  ds_read_b64_tr_b16 v[108:109], v1 offset:8224
  ds_read_b64_tr_b16 v[110:111], v1 offset:8480
  ds_read_b64_tr_b16 v[112:113], v1 offset:10272
  ds_read_b64_tr_b16 v[114:115], v1 offset:10528
  ds_read_b64_tr_b16 v[116:117], v1 offset:12320
  ds_read_b64_tr_b16 v[118:119], v1 offset:12576
  v_lshlrev_b32 v23, 4, v0
  v_add_u32 v23, 104448, v23
  ds_read_b128 v[124:127], v23 offset:5120
  s_waitcnt lgkmcnt(0)
  s_branch L_p1
L_p3:
  s_setprio 3
  s_cmp_eq_u32 s32, 0
  s_cbranch_scc1 L_p3_w
  s_waitcnt vmcnt(0)
  s_cmp_eq_u32 s32, 0
  s_cbranch_scc1 L_p3_w
  ds_read_b64_tr_b16 v[64:65], v1 offset:14336
  ds_read_b64_tr_b16 v[66:67], v1 offset:14592
  ds_read_b64_tr_b16 v[68:69], v1 offset:16384
  ds_read_b64_tr_b16 v[70:71], v1 offset:16640
  ds_read_b64_tr_b16 v[72:73], v1 offset:18432
  ds_read_b64_tr_b16 v[74:75], v1 offset:18688
  ds_read_b64_tr_b16 v[76:77], v1 offset:20480
  ds_read_b64_tr_b16 v[78:79], v1 offset:20736
  ds_read_b64_tr_b16 v[80:81], v1 offset:22528
  ds_read_b64_tr_b16 v[82:83], v1 offset:22784
  ds_read_b64_tr_b16 v[84:85], v1 offset:24576
  ds_read_b64_tr_b16 v[86:87], v1 offset:24832
  ds_read_b64_tr_b16 v[88:89], v1 offset:26624
  ds_read_b64_tr_b16 v[90:91], v1 offset:26880
  ds_read_b64_tr_b16 v[92:93], v1 offset:28672
  ds_read_b64_tr_b16 v[94:95], v1 offset:28928
  ds_read_b64_tr_b16 v[96:97], v1 offset:14368
  ds_read_b64_tr_b16 v[98:99], v1 offset:14624
  ds_read_b64_tr_b16 v[100:101], v1 offset:16416
  ds_read_b64_tr_b16 v[102:103], v1 offset:16672
  ds_read_b64_tr_b16 v[104:105], v1 offset:18464
  ds_read_b64_tr_b16 v[106:107], v1 offset:18720
  ds_read_b64_tr_b16 v[108:109], v1 offset:20512
  ds_read_b64_tr_b16 v[110:111], v1 offset:20768
  ds_read_b64_tr_b16 v[112:113], v1 offset:22560
  ds_read_b64_tr_b16 v[114:115], v1 offset:22816
  ds_read_b64_tr_b16 v[116:117], v1 offset:24608
  ds_read_b64_tr_b16 v[118:119], v1 offset:24864
  ds_read_b64_tr_b16 v[120:121], v1 offset:26656
  ds_read_b64_tr_b16 v[122:123], v1 offset:26912
  ds_read_b64_tr_b16 v[124:125], v1 offset:28704
  ds_read_b64_tr_b16 v[126:127], v1 offset:28960
L_p3_w:
  v_and_b32 v24, 16, v0
  v_lshl_add_u32 v24, v24, 3, v14
  s_waitcnt vmcnt(3)
  s_barrier
  s_cmp_eq_u32 s32, 0
  s_cbranch_scc0 L_mlok
  s_cmp_eq_u32 s30, 0
  s_cbranch_scc0 L_mle
  global_load_dwordx2 v[2:3], v24, s[40:41] sc1
L_mle:
  ds_read_b64_tr_b16 v[64:65], v1 offset:14336
  ds_read_b64_tr_b16 v[66:67], v1 offset:14592
  ds_read_b64_tr_b16 v[68:69], v1 offset:16384
  ds_read_b64_tr_b16 v[70:71], v1 offset:16640
  ds_read_b64_tr_b16 v[72:73], v1 offset:18432
  ds_read_b64_tr_b16 v[74:75], v1 offset:18688
  ds_read_b64_tr_b16 v[76:77], v1 offset:20480
  ds_read_b64_tr_b16 v[78:79], v1 offset:20736
  ds_read_b64_tr_b16 v[80:81], v1 offset:22528
  ds_read_b64_tr_b16 v[82:83], v1 offset:22784
  ds_read_b64_tr_b16 v[84:85], v1 offset:24576
  ds_read_b64_tr_b16 v[86:87], v1 offset:24832
  ds_read_b64_tr_b16 v[88:89], v1 offset:26624
  ds_read_b64_tr_b16 v[90:91], v1 offset:26880
  ds_read_b64_tr_b16 v[92:93], v1 offset:28672
  ds_read_b64_tr_b16 v[94:95], v1 offset:28928
  ds_read_b64_tr_b16 v[96:97], v1 offset:14368
  ds_read_b64_tr_b16 v[98:99], v1 offset:14624
  ds_read_b64_tr_b16 v[100:101], v1 offset:16416
  ds_read_b64_tr_b16 v[102:103], v1 offset:16672
  ds_read_b64_tr_b16 v[104:105], v1 offset:18464
  ds_read_b64_tr_b16 v[106:107], v1 offset:18720
  ds_read_b64_tr_b16 v[108:109], v1 offset:20512
  ds_read_b64_tr_b16 v[110:111], v1 offset:20768
  ds_read_b64_tr_b16 v[112:113], v1 offset:22560
  ds_read_b64_tr_b16 v[114:115], v1 offset:22816
  ds_read_b64_tr_b16 v[116:117], v1 offset:24608
  ds_read_b64_tr_b16 v[118:119], v1 offset:24864
  ds_read_b64_tr_b16 v[120:121], v1 offset:26656
  ds_read_b64_tr_b16 v[122:123], v1 offset:26912
  ds_read_b64_tr_b16 v[124:125], v1 offset:28704
  ds_read_b64_tr_b16 v[126:127], v1 offset:28960
  v_mov_b32 v25, 70784
  s_cmp_eq_u32 s30, 0
  s_cbranch_scc0 L_mlw1
  s_branch L_mlc
L_ml0:
  global_load_dwordx2 v[2:3], v24, s[40:41] sc1
  s_add_u32 s33, s33, 1
  s_cmp_gt_u32 s33, 400000
  s_cbranch_scc1 L_exit
L_mlc:
  s_waitcnt vmcnt(0)
  v_max_u32 v26, v2, v3
  v_cmp_eq_u32 vcc, -1, v26
  s_cbranch_vccz L_ml1
  s_branch L_ml0
L_ml1:
  ds_write_b32 v25, v25 offset:24
  s_branch L_mlok
L_mlw1:
  ds_read_b32 v24, v25 offset:24
  s_add_u32 s33, s33, 1
  s_cmp_gt_u32 s33, 400000
  s_cbranch_scc1 L_exit
  s_waitcnt lgkmcnt(0)
  v_cmp_eq_u32 vcc, 0, v24
  s_cbranch_vccz L_mlok
  s_branch L_mlw1
L_mlpoll:
L_mlp2:
  global_load_dwordx2 v[2:3], v14, s[40:41] sc1
  s_add_u32 s33, s33, 1
  s_cmp_gt_u32 s33, 400000
  s_cbranch_scc1 L_exit
  s_waitcnt vmcnt(0)
  v_max_u32 v26, v2, v3
  v_cmp_eq_u32 vcc, -1, v26
  s_cbranch_vccnz L_mlp2
L_mlok:
  s_cmp_eq_u32 s66, 0
  s_cbranch_scc1 NOBO_10
  s_sleep 2
NOBO_10:
  global_load_dwordx2 v[2:3], v14, s[40:41] sc1
  global_load_dwordx4 v[32:35], v13, s[40:41] offset:-4096 sc1
  global_load_dwordx4 v[36:39], v13, s[40:41] offset:-3072 sc1
  global_load_dwordx4 v[40:43], v13, s[40:41] offset:-2048 sc1
  global_load_dwordx4 v[44:47], v13, s[40:41] offset:-1024 sc1
  global_load_dwordx4 v[48:51], v13, s[40:41] offset:0 sc1
  global_load_dwordx4 v[52:55], v13, s[40:41] offset:1024 sc1
  global_load_dwordx4 v[56:59], v13, s[40:41] offset:2048 sc1
  global_load_dwordx4 v[60:63], v13, s[40:41] offset:3072 sc1
  s_mov_b32 s64, 0
  s_waitcnt lgkmcnt(0)
  s_cmp_eq_u32 s32, 0
  s_cbranch_scc0 NOG_11
  s_waitcnt vmcnt(0)
  s_branch COMP_5
NOG_11:
  s_sleep 4
  global_load_dwordx2 v[2:3], v14, s[40:41] sc1
  global_load_dwordx4 v[32:35], v13, s[40:41] offset:-4096 sc1
  global_load_dwordx4 v[36:39], v13, s[40:41] offset:-3072 sc1
  global_load_dwordx4 v[40:43], v13, s[40:41] offset:-2048 sc1
  global_load_dwordx4 v[44:47], v13, s[40:41] offset:-1024 sc1
  global_load_dwordx4 v[48:51], v13, s[40:41] offset:0 sc1
  global_load_dwordx4 v[52:55], v13, s[40:41] offset:1024 sc1
  global_load_dwordx4 v[56:59], v13, s[40:41] offset:2048 sc1
  global_load_dwordx4 v[60:63], v13, s[40:41] offset:3072 sc1
COMP_5:
  s_waitcnt vmcnt(17)
  v_max_u32 v26, v2, v3
  v_cmp_eq_u32 vcc, -1, v26
  s_cbranch_vccnz AGAIN_9
  s_cmp_eq_u32 s31, 0
  s_waitcnt vmcnt(16)
  v_mfma_f32_16x16x32_bf16 v[16:19], v[64:67], v[32:35], 0
  v_mfma_f32_16x16x32_bf16 v[20:23], v[96:99], v[32:35], 0
  v_max_f32_dpp v26, v2, v2 quad_perm:[1,0,3,2] row_mask:0xf bank_mask:0xf
  s_waitcnt vmcnt(15)
  v_mfma_f32_16x16x32_bf16 v[16:19], v[68:71], v[36:39], v[16:19]
  v_mfma_f32_16x16x32_bf16 v[20:23], v[100:103], v[36:39], v[20:23]
  v_max_f32_dpp v26, v26, v26 quad_perm:[2,3,0,1] row_mask:0xf bank_mask:0xf
  s_waitcnt vmcnt(14)
  v_mfma_f32_16x16x32_bf16 v[16:19], v[72:75], v[40:43], v[16:19]
  v_mfma_f32_16x16x32_bf16 v[20:23], v[104:107], v[40:43], v[20:23]
  v_sub_f32 v26, v2, v26
  s_waitcnt vmcnt(13)
  v_mfma_f32_16x16x32_bf16 v[16:19], v[76:79], v[44:47], v[16:19]
  v_mfma_f32_16x16x32_bf16 v[20:23], v[108:111], v[44:47], v[20:23]
  v_exp_f32 v26, v26
  s_waitcnt vmcnt(12)
  v_mfma_f32_16x16x32_bf16 v[16:19], v[80:83], v[48:51], v[16:19]
  v_mfma_f32_16x16x32_bf16 v[20:23], v[112:115], v[48:51], v[20:23]
  v_mul_f32 v27, v26, v3
  s_waitcnt vmcnt(11)
  v_mfma_f32_16x16x32_bf16 v[16:19], v[84:87], v[52:55], v[16:19]
  v_mfma_f32_16x16x32_bf16 v[20:23], v[116:119], v[52:55], v[20:23]
  v_add_f32_dpp v27, v27, v27 quad_perm:[1,0,3,2] row_mask:0xf bank_mask:0xf
  s_waitcnt vmcnt(10)
  v_mfma_f32_16x16x32_bf16 v[16:19], v[88:91], v[56:59], v[16:19]
  v_mfma_f32_16x16x32_bf16 v[20:23], v[120:123], v[56:59], v[20:23]
  v_add_f32_dpp v27, v27, v27 quad_perm:[2,3,0,1] row_mask:0xf bank_mask:0xf
  s_waitcnt vmcnt(9)
  v_mfma_f32_16x16x32_bf16 v[16:19], v[92:95], v[60:63], v[16:19]
  v_mfma_f32_16x16x32_bf16 v[20:23], v[124:127], v[60:63], v[20:23]
  v_rcp_f32 v27, v27
  s_nop 0
  v_mul_f32 v26, v26, v27
  s_nop 3
  v_mul_f32 v16, v16, v26
  v_mul_f32 v17, v17, v26
  v_mul_f32 v18, v18, v26
  v_mul_f32 v19, v19, v26
  v_mul_f32 v20, v20, v26
  v_mul_f32 v21, v21, v26
  v_mul_f32 v22, v22, v26
  v_mul_f32 v23, v23, v26
  v_add_f32_dpp v16, v16, v16 quad_perm:[1,0,3,2] row_mask:0xf bank_mask:0xf
  v_add_f32_dpp v17, v17, v17 quad_perm:[1,0,3,2] row_mask:0xf bank_mask:0xf
  v_add_f32_dpp v18, v18, v18 quad_perm:[1,0,3,2] row_mask:0xf bank_mask:0xf
  v_add_f32_dpp v19, v19, v19 quad_perm:[1,0,3,2] row_mask:0xf bank_mask:0xf
  v_add_f32_dpp v20, v20, v20 quad_perm:[1,0,3,2] row_mask:0xf bank_mask:0xf
  v_add_f32_dpp v21, v21, v21 quad_perm:[1,0,3,2] row_mask:0xf bank_mask:0xf
  v_add_f32_dpp v22, v22, v22 quad_perm:[1,0,3,2] row_mask:0xf bank_mask:0xf
  v_add_f32_dpp v23, v23, v23 quad_perm:[1,0,3,2] row_mask:0xf bank_mask:0xf
  v_cndmask_b32 v16, v16, v20, s[58:59]
  v_cndmask_b32 v17, v17, v21, s[58:59]
  v_cndmask_b32 v18, v18, v22, s[58:59]
  v_cndmask_b32 v19, v19, v23, s[58:59]
  v_add_f32_dpp v16, v16, v16 quad_perm:[2,3,0,1] row_mask:0xf bank_mask:0xf
  v_add_f32_dpp v17, v17, v17 quad_perm:[2,3,0,1] row_mask:0xf bank_mask:0xf
  v_add_f32_dpp v18, v18, v18 quad_perm:[2,3,0,1] row_mask:0xf bank_mask:0xf
  v_add_f32_dpp v19, v19, v19 quad_perm:[2,3,0,1] row_mask:0xf bank_mask:0xf
  v_cmp_u_f32 vcc, v16, v16
  s_cbranch_vccnz RETRY_6
OK_7:
  global_store_dwordx4 v15, v[16:19], s[40:41] sc1
  s_cmp_eq_u32 s30, 1
  s_cbranch_scc0 L_chain
  v_mov_b32 v24, 70784
  ds_write_b32 v24, v24 offset:28
  s_setprio 0
  s_branch L_next
L_chain:
  v_mov_b32 v6, 70784
  ds_read_b64 v[6:7], v6 offset:16
  v_lshlrev_b32 v4, 4, v0
  v_add_u32 v4, 104448, v4
  ds_read_b64 v[28:29], v4 offset:3072
  ds_read_b128 v[16:19], v4 offset:0
  ds_read_b128 v[20:23], v4 offset:1024
  ds_read_b128 v[24:27], v4 offset:2048
  s_add_u32 s42, s40, 16384
  s_addc_u32 s43, s41, 0
  s_waitcnt lgkmcnt(0)
  v_cmp_lt_u32 vcc, v7, v6
  v_and_b32 v12, 4294959103, v12
  v_or_b32 v6, 8192, v12
  v_cndmask_b32 v12, v12, v6, vcc
  s_cmp_eq_u64 vcc, 0
  s_cselect_b32 s66, 0, 8192
  s_cmp_eq_u32 s66, s35
  s_cselect_b32 s66, 1, 0
  v_mov_b32 v4, 0
  v_mov_b32 v5, 0
  v_mov_b32 v6, 0
  v_mov_b32 v7, 0
  v_mov_b32 v8, 0
  v_mov_b32 v9, 0
  v_mov_b32 v10, 0
  v_mov_b32 v11, 0
  s_cmp_eq_u32 s32, 0
  s_cbranch_scc0 L_r1_nb
  s_barrier
L_r1_nb:
  s_waitcnt vmcnt(0)
  global_load_dwordx4 v[32:35], v12, s[40:41] offset:-4096 sc1
  global_load_dwordx4 v[36:39], v12, s[40:41] offset:-3072 sc1
  global_load_dwordx4 v[40:43], v12, s[40:41] offset:-2048 sc1
  global_load_dwordx4 v[44:47], v12, s[40:41] offset:-1024 sc1
  global_load_dwordx4 v[48:51], v12, s[40:41] offset:0 sc1
  global_load_dwordx4 v[52:55], v12, s[40:41] offset:1024 sc1
  global_load_dwordx4 v[56:59], v12, s[40:41] offset:2048 sc1
  global_load_dwordx4 v[60:63], v12, s[40:41] offset:3072 sc1
  s_mov_b32 s64, 0
  s_cmp_eq_u32 s32, 0
  s_cbranch_scc1 L_r1_skip
  ds_read_b64_tr_b16 v[64:65], v29 offset:30720
  ds_read_b64_tr_b16 v[66:67], v29 offset:30784
  ds_read_b64_tr_b16 v[68:69], v29 offset:31232
  ds_read_b64_tr_b16 v[70:71], v29 offset:31296
  ds_read_b64_tr_b16 v[72:73], v29 offset:31744
  ds_read_b64_tr_b16 v[74:75], v29 offset:31808
  ds_read_b64_tr_b16 v[76:77], v29 offset:32256
  ds_read_b64_tr_b16 v[78:79], v29 offset:32320
  ds_read_b64_tr_b16 v[80:81], v29 offset:32768
  ds_read_b64_tr_b16 v[82:83], v29 offset:32832
  ds_read_b64_tr_b16 v[84:85], v29 offset:33280
  ds_read_b64_tr_b16 v[86:87], v29 offset:33344
  ds_read_b64_tr_b16 v[88:89], v29 offset:33792
  ds_read_b64_tr_b16 v[90:91], v29 offset:33856
  ds_read_b64_tr_b16 v[92:93], v29 offset:34304
  ds_read_b64_tr_b16 v[94:95], v29 offset:34368
  ds_read_b64_tr_b16 v[96:97], v29 offset:34816
  ds_read_b64_tr_b16 v[98:99], v29 offset:34880
  ds_read_b64_tr_b16 v[100:101], v29 offset:35328
  ds_read_b64_tr_b16 v[102:103], v29 offset:35392
  ds_read_b64_tr_b16 v[104:105], v29 offset:35840
  ds_read_b64_tr_b16 v[106:107], v29 offset:35904
  ds_read_b64_tr_b16 v[108:109], v29 offset:36352
  ds_read_b64_tr_b16 v[110:111], v29 offset:36416
  ds_read_b64_tr_b16 v[112:113], v29 offset:36864
  ds_read_b64_tr_b16 v[114:115], v29 offset:36928
  ds_read_b64_tr_b16 v[116:117], v29 offset:37376
  ds_read_b64_tr_b16 v[118:119], v29 offset:37440
  v_lshlrev_b32 v23, 4, v0
  v_add_u32 v23, 104448, v23
  ds_read_b128 v[124:127], v23 offset:4096
  s_waitcnt lgkmcnt(0)
  s_branch L_r1_go
L_r1_skip:
  ds_read_b64_tr_b16 v[64:65], v29 offset:30720
  ds_read_b64_tr_b16 v[66:67], v29 offset:30784
  ds_read_b64_tr_b16 v[68:69], v29 offset:31232
  ds_read_b64_tr_b16 v[70:71], v29 offset:31296
  ds_read_b64_tr_b16 v[72:73], v29 offset:31744
  ds_read_b64_tr_b16 v[74:75], v29 offset:31808
  ds_read_b64_tr_b16 v[76:77], v29 offset:32256
  ds_read_b64_tr_b16 v[78:79], v29 offset:32320
  ds_read_b64_tr_b16 v[80:81], v29 offset:32768
  ds_read_b64_tr_b16 v[82:83], v29 offset:32832
  ds_read_b64_tr_b16 v[84:85], v29 offset:33280
  ds_read_b64_tr_b16 v[86:87], v29 offset:33344
  ds_read_b64_tr_b16 v[88:89], v29 offset:33792
  ds_read_b64_tr_b16 v[90:91], v29 offset:33856
  ds_read_b64_tr_b16 v[92:93], v29 offset:34304
  ds_read_b64_tr_b16 v[94:95], v29 offset:34368
  ds_read_b64_tr_b16 v[96:97], v29 offset:34816
  ds_read_b64_tr_b16 v[98:99], v29 offset:34880
  ds_read_b64_tr_b16 v[100:101], v29 offset:35328
  ds_read_b64_tr_b16 v[102:103], v29 offset:35392
  ds_read_b64_tr_b16 v[104:105], v29 offset:35840
  ds_read_b64_tr_b16 v[106:107], v29 offset:35904
  ds_read_b64_tr_b16 v[108:109], v29 offset:36352
  ds_read_b64_tr_b16 v[110:111], v29 offset:36416
  ds_read_b64_tr_b16 v[112:113], v29 offset:36864
  ds_read_b64_tr_b16 v[114:115], v29 offset:36928
  ds_read_b64_tr_b16 v[116:117], v29 offset:37376
  ds_read_b64_tr_b16 v[118:119], v29 offset:37440
  v_lshlrev_b32 v23, 4, v0
  v_add_u32 v23, 104448, v23
  v_mov_b32 v120, 0x3f803f80
  v_mov_b32 v121, 0x3f803f80
  v_mov_b32 v122, 0x3f803f80
  v_mov_b32 v123, 0x3f803f80
  s_waitcnt lgkmcnt(0)
  s_nop 0
  v_mfma_f32_16x16x32_bf16 v[124:127], v[64:67], v[120:123], 0
  v_mfma_f32_16x16x32_bf16 v[124:127], v[68:71], v[120:123], v[124:127]
  v_mfma_f32_16x16x32_bf16 v[124:127], v[72:75], v[120:123], v[124:127]
  v_mfma_f32_16x16x32_bf16 v[124:127], v[76:79], v[120:123], v[124:127]
  v_mfma_f32_16x16x32_bf16 v[124:127], v[80:83], v[120:123], v[124:127]
  v_mfma_f32_16x16x32_bf16 v[124:127], v[84:87], v[120:123], v[124:127]
  v_mfma_f32_16x16x32_bf16 v[124:127], v[88:91], v[120:123], v[124:127]
  v_mfma_f32_16x16x32_bf16 v[124:127], v[92:95], v[120:123], v[124:127]
  v_mfma_f32_16x16x32_bf16 v[124:127], v[96:99], v[120:123], v[124:127]
  v_mfma_f32_16x16x32_bf16 v[124:127], v[100:103], v[120:123], v[124:127]
  v_mfma_f32_16x16x32_bf16 v[124:127], v[104:107], v[120:123], v[124:127]
  v_mfma_f32_16x16x32_bf16 v[124:127], v[108:111], v[120:123], v[124:127]
  v_mfma_f32_16x16x32_bf16 v[124:127], v[112:115], v[120:123], v[124:127]
  v_mfma_f32_16x16x32_bf16 v[124:127], v[116:119], v[120:123], v[124:127]
  s_nop 7
  ds_write_b128 v23, v[124:127] offset:4096
L_r1_go:
  s_sleep 4
  global_load_dwordx4 v[32:35], v12, s[40:41] offset:-4096 sc1
  global_load_dwordx4 v[36:39], v12, s[40:41] offset:-3072 sc1
  global_load_dwordx4 v[40:43], v12, s[40:41] offset:-2048 sc1
  global_load_dwordx4 v[44:47], v12, s[40:41] offset:-1024 sc1
  global_load_dwordx4 v[48:51], v12, s[40:41] offset:0 sc1
  global_load_dwordx4 v[52:55], v12, s[40:41] offset:1024 sc1
  global_load_dwordx4 v[56:59], v12, s[40:41] offset:2048 sc1
  global_load_dwordx4 v[60:63], v12, s[40:41] offset:3072 sc1
COMP_12:
  s_cmp_eq_u32 s31, 0
  s_waitcnt vmcnt(14)
  v_pk_add_f32 v[120:121], v[32:33], v[36:37]
  v_pk_add_f32 v[122:123], v[34:35], v[38:39]
  s_waitcnt vmcnt(13)
  v_pk_add_f32 v[120:121], v[120:121], v[40:41]
  v_pk_add_f32 v[122:123], v[122:123], v[42:43]
  s_waitcnt vmcnt(12)
  v_pk_add_f32 v[120:121], v[120:121], v[44:45]
  v_pk_add_f32 v[122:123], v[122:123], v[46:47]
  s_waitcnt vmcnt(11)
  v_pk_add_f32 v[120:121], v[120:121], v[48:49]
  v_pk_add_f32 v[122:123], v[122:123], v[50:51]
  s_waitcnt vmcnt(10)
  v_pk_add_f32 v[120:121], v[120:121], v[52:53]
  v_pk_add_f32 v[122:123], v[122:123], v[54:55]
  s_waitcnt vmcnt(9)
  v_pk_add_f32 v[120:121], v[120:121], v[56:57]
  v_pk_add_f32 v[122:123], v[122:123], v[58:59]
  s_waitcnt vmcnt(8)
  v_pk_add_f32 v[120:121], v[120:121], v[60:61]
  v_pk_add_f32 v[122:123], v[122:123], v[62:63]
  s_nop 1
  v_permlane32_swap_b32 v120, v122
  v_permlane32_swap_b32 v121, v123
  v_pk_add_f32 v[120:121], v[120:121], v[122:123]
  v_pk_add_f32 v[120:121], v[120:121], v[30:31]
  v_cvt_pk_bf16_f32 v122, v120, v121
  v_min_u32 v122, -2, v122
  v_cmp_u_f32 vcc, v120, v121
  s_cbranch_vccnz RETRY_13
OK_14:
  s_cbranch_scc1 SLOW_17
  global_store_dword v16, v122, s[40:41]
BACK_18:
  v_lshlrev_b32 v30, 16, v122
  v_and_b32 v31, 0xffff0000, v122
  v_add_f32 v120, v30, v31
  v_mul_f32 v121, v30, v30
  v_fmac_f32 v121, v31, v31
  s_nop 1
  v_permlane32_swap_b32 v120, v121
  v_add_f32 v120, v120, v121
  s_nop 1
  v_add_f32_dpp v120, v120, v120 quad_perm:[1,0,3,2] row_mask:0xf bank_mask:0xf
  s_nop 1
  v_add_f32_dpp v120, v120, v120 quad_perm:[2,3,0,1] row_mask:0xf bank_mask:0xf
  s_cbranch_scc1 SLOW_19
  s_mov_b64 exec, s[54:55]
  global_store_dword v17, v120, s[40:41] offset:0
  s_mov_b64 exec, -1
BACK_20:
  s_cmp_eq_u32 s66, 0
  s_cbranch_scc1 NOBO_26
  s_sleep 2
NOBO_26:
  s_mov_b64 exec, s[56:57]
  global_load_dwordx4 v[4:7], v19, s[40:41] offset:0 sc1
  global_load_dwordx4 v[8:11], v19, s[40:41] offset:1024 sc1
  s_mov_b64 exec, -1
  global_load_dwordx4 v[32:35], v18, s[40:41] offset:0 sc1
  global_load_dwordx4 v[36:39], v18, s[40:41] offset:512 sc1
  global_load_dwordx4 v[40:43], v18, s[40:41] offset:1024 sc1
  global_load_dwordx4 v[44:47], v18, s[40:41] offset:1536 sc1
  global_load_dwordx4 v[48:51], v18, s[40:41] offset:2048 sc1
  global_load_dwordx4 v[52:55], v18, s[40:41] offset:2560 sc1
  global_load_dwordx4 v[56:59], v18, s[40:41] offset:3072 sc1
  s_mov_b32 s64, 0
  s_sleep 4
  s_mov_b64 exec, s[56:57]
  global_load_dwordx4 v[4:7], v19, s[40:41] offset:0 sc1
  global_load_dwordx4 v[8:11], v19, s[40:41] offset:1024 sc1
  s_mov_b64 exec, -1
  global_load_dwordx4 v[32:35], v18, s[40:41] offset:0 sc1
  global_load_dwordx4 v[36:39], v18, s[40:41] offset:512 sc1
  global_load_dwordx4 v[40:43], v18, s[40:41] offset:1024 sc1
  global_load_dwordx4 v[44:47], v18, s[40:41] offset:1536 sc1
  global_load_dwordx4 v[48:51], v18, s[40:41] offset:2048 sc1
  global_load_dwordx4 v[52:55], v18, s[40:41] offset:2560 sc1
  global_load_dwordx4 v[56:59], v18, s[40:41] offset:3072 sc1
COMP_21:
  s_waitcnt vmcnt(16)
  v_max3_u32 v2, v4, v5, v6
  v_max3_u32 v2, v7, v8, v2
  v_max3_u32 v2, v9, v10, v2
  v_max_u32 v2, v11, v2
  v_cmp_eq_u32 vcc, -1, v2
  s_cbranch_vccnz AGAIN_25
  s_cmp_eq_u32 s31, 0
  s_waitcnt vmcnt(15)
  v_mfma_f32_16x16x32_bf16 v[60:63], v[64:67], v[32:35], 0
  v_pk_add_f32 v[2:3], v[4:5], v[6:7]
  v_mfma_f32_16x16x32_bf16 v[120:123], v[92:95], v[32:35], 0
  v_pk_add_f32 v[2:3], v[2:3], v[8:9]
  s_waitcnt vmcnt(14)
  v_mfma_f32_16x16x32_bf16 v[60:63], v[68:71], v[36:39], v[60:63]
  v_pk_add_f32 v[2:3], v[2:3], v[10:11]
  v_mfma_f32_16x16x32_bf16 v[120:123], v[96:99], v[36:39], v[120:123]
  s_nop 0
  v_permlane32_swap_b32 v2, v3
  s_waitcnt vmcnt(13)
  v_mfma_f32_16x16x32_bf16 v[60:63], v[72:75], v[40:43], v[60:63]
  v_add_f32 v2, v2, v3
  v_mfma_f32_16x16x32_bf16 v[120:123], v[100:103], v[40:43], v[120:123]
  v_mov_b32 v3, v2
  s_waitcnt vmcnt(12)
  v_mfma_f32_16x16x32_bf16 v[60:63], v[76:79], v[44:47], v[60:63]
  v_permlane16_swap_b32 v2, v3
  v_mfma_f32_16x16x32_bf16 v[120:123], v[104:107], v[44:47], v[120:123]
  v_add_f32 v2, v2, v3
  s_waitcnt vmcnt(11)
  v_mfma_f32_16x16x32_bf16 v[60:63], v[80:83], v[48:51], v[60:63]
  v_add_f32_dpp v2, v2, v2 row_ror:8 row_mask:0xf bank_mask:0xf
  v_mfma_f32_16x16x32_bf16 v[120:123], v[108:111], v[48:51], v[120:123]
  v_mul_f32 v2, s61, v2
  s_waitcnt vmcnt(10)
  v_mfma_f32_16x16x32_bf16 v[60:63], v[84:87], v[52:55], v[60:63]
  v_mov_b32 v3, v2
  v_mfma_f32_16x16x32_bf16 v[120:123], v[112:115], v[52:55], v[120:123]
  s_nop 0
  v_permlane32_swap_b32 v2, v3
  s_waitcnt vmcnt(9)
  v_mfma_f32_16x16x32_bf16 v[60:63], v[88:91], v[56:59], v[60:63]
  v_fma_f32 v3, -v2, v2, v3
  v_mfma_f32_16x16x32_bf16 v[120:123], v[116:119], v[56:59], v[120:123]
  v_add_f32 v3, s62, v3
  v_max_f32 v23, s62, v3
  v_rsq_f32 v23, v23
  s_nop 0
  v_fma_f32 v3, v3, 0, v23
  s_nop 2
  v_add_f32_dpp v60, v120, v60 row_ror:8 row_mask:0xf bank_mask:0xf
  v_add_f32_dpp v61, v121, v61 row_ror:8 row_mask:0xf bank_mask:0xf
  v_add_f32_dpp v62, v122, v62 row_ror:8 row_mask:0xf bank_mask:0xf
  v_add_f32_dpp v63, v123, v63 row_ror:8 row_mask:0xf bank_mask:0xf
  v_fma_f32 v60, -v2, v124, v60
  v_fma_f32 v61, -v2, v125, v61
  v_fma_f32 v62, -v2, v126, v62
  v_fma_f32 v63, -v2, v127, v63
  v_mul_f32 v23, s63, v3
  v_permlane32_swap_b32 v60, v62
  v_permlane32_swap_b32 v61, v63
  v_mul_f32 v60, v23, v60
  v_mul_f32 v61, v23, v61
  v_exp_f32 v60, v60
  v_exp_f32 v61, v61
  v_mul_f32 v62, v3, v62
  v_mul_f32 v63, v3, v63
  v_add_f32 v60, 1.0, v60
  v_add_f32 v61, 1.0, v61
  v_rcp_f32 v60, v60
  v_rcp_f32 v61, v61
  v_mul_f32 v60, v60, v62
  v_mul_f32 v61, v61, v63
  v_cvt_pk_bf16_f32 v62, v60, v61
  v_min_u32 v62, -2, v62
  v_cmp_u_f32 vcc, v60, v61
  s_cbranch_vccnz RETRY_22
OK_23:
  s_cbranch_scc1 SLOW_27
  s_mov_b64 exec, s[52:53]
  global_store_dword v20, v62, s[40:41]
  s_mov_b64 exec, -1
BACK_28:
  s_cmp_eq_u32 s66, 0
  s_cbranch_scc1 NOBO_34
  s_sleep 2
NOBO_34:
  global_load_dwordx4 v[32:35], v21, s[40:41] offset:0 sc1
  global_load_dwordx4 v[36:39], v21, s[40:41] offset:512 sc1
  global_load_dwordx4 v[40:43], v21, s[40:41] offset:1024 sc1
  global_load_dwordx4 v[44:47], v21, s[40:41] offset:1536 sc1
  s_mov_b32 s64, 0
  ds_read_b64_tr_b16 v[64:65], v28 offset:45056
  ds_read_b64_tr_b16 v[66:67], v28 offset:45184
  ds_read_b64_tr_b16 v[68:69], v28 offset:46080
  ds_read_b64_tr_b16 v[70:71], v28 offset:46208
  ds_read_b64_tr_b16 v[72:73], v28 offset:47104
  ds_read_b64_tr_b16 v[74:75], v28 offset:47232
  ds_read_b64_tr_b16 v[76:77], v28 offset:48128
  ds_read_b64_tr_b16 v[78:79], v28 offset:48256
  ds_read_b64_tr_b16 v[80:81], v28 offset:49152
  ds_read_b64_tr_b16 v[82:83], v28 offset:49280
  ds_read_b64_tr_b16 v[84:85], v28 offset:50176
  ds_read_b64_tr_b16 v[86:87], v28 offset:50304
  ds_read_b64_tr_b16 v[88:89], v28 offset:51200
  ds_read_b64_tr_b16 v[90:91], v28 offset:51328
  s_waitcnt lgkmcnt(0)
  s_sleep 4
  global_load_dwordx4 v[32:35], v21, s[40:41] offset:0 sc1
  global_load_dwordx4 v[36:39], v21, s[40:41] offset:512 sc1
  global_load_dwordx4 v[40:43], v21, s[40:41] offset:1024 sc1
  global_load_dwordx4 v[44:47], v21, s[40:41] offset:1536 sc1
COMP_29:
  s_cmp_eq_u32 s31, 0
  s_waitcnt vmcnt(7)
  v_mfma_f32_16x16x32_bf16 v[60:63], v[64:67], v[32:35], 0
  s_waitcnt vmcnt(6)
  v_mfma_f32_16x16x32_bf16 v[60:63], v[68:71], v[36:39], v[60:63]
  v_mfma_f32_16x16x32_bf16 v[120:123], v[80:83], v[36:39], 0
  s_waitcnt vmcnt(5)
  v_mfma_f32_16x16x32_bf16 v[60:63], v[72:75], v[40:43], v[60:63]
  v_mfma_f32_16x16x32_bf16 v[120:123], v[84:87], v[40:43], v[120:123]
  s_waitcnt vmcnt(4)
  v_mfma_f32_16x16x32_bf16 v[60:63], v[76:79], v[44:47], v[60:63]
  v_mfma_f32_16x16x32_bf16 v[120:123], v[88:91], v[44:47], v[120:123]
  s_nop 7
  v_add_f32_dpp v48, v120, v60 row_ror:8 row_mask:0xf bank_mask:0x3
  v_add_f32_dpp v49, v121, v61 row_ror:8 row_mask:0xf bank_mask:0x3
  v_add_f32_dpp v50, v122, v62 row_ror:8 row_mask:0xf bank_mask:0x3
  v_add_f32_dpp v51, v123, v63 row_ror:8 row_mask:0xf bank_mask:0x3
  v_add_f32_dpp v48, v60, v120 row_ror:8 row_mask:0xf bank_mask:0xc
  v_add_f32_dpp v49, v61, v121 row_ror:8 row_mask:0xf bank_mask:0xc
  v_add_f32_dpp v50, v62, v122 row_ror:8 row_mask:0xf bank_mask:0xc
  v_add_f32_dpp v51, v63, v123 row_ror:8 row_mask:0xf bank_mask:0xc
  v_cmp_u_f32 vcc, v48, v48
  s_cbranch_vccnz RETRY_30
OK_31:
  global_store_dwordx4 v22, v[48:51], s[40:41] sc1
  v_mov_b32 v120, 70784
  ds_read_b64 v[120:121], v120 offset:16
  s_waitcnt lgkmcnt(0)
  v_cmp_lt_u32 vcc, v121, v120
  v_and_b32 v24, 4294959103, v24
  v_or_b32 v120, 8192, v24
  v_cndmask_b32 v24, v24, v120, vcc
  s_cmp_eq_u64 vcc, 0
  s_cselect_b32 s66, 0, 8192
  s_cmp_eq_u32 s66, s35
  s_cselect_b32 s66, 1, 0
  s_waitcnt vmcnt(0)
  global_load_dwordx4 v[32:35], v24, s[40:41] offset:0 sc1
  global_load_dwordx4 v[36:39], v24, s[40:41] offset:1024 sc1
  global_load_dwordx4 v[40:43], v24, s[40:41] offset:2048 sc1
  global_load_dwordx4 v[44:47], v24, s[40:41] offset:3072 sc1
  s_mov_b32 s64, 0
  s_cmp_eq_u32 s32, 1
  s_cbranch_scc1 L_r2_skip
  ds_read_b64_tr_b16 v[64:65], v1 offset:0
  ds_read_b64_tr_b16 v[66:67], v1 offset:256
  ds_read_b64_tr_b16 v[68:69], v1 offset:2048
  ds_read_b64_tr_b16 v[70:71], v1 offset:2304
  ds_read_b64_tr_b16 v[72:73], v1 offset:4096
  ds_read_b64_tr_b16 v[74:75], v1 offset:4352
  ds_read_b64_tr_b16 v[76:77], v1 offset:6144
  ds_read_b64_tr_b16 v[78:79], v1 offset:6400
  ds_read_b64_tr_b16 v[80:81], v1 offset:8192
  ds_read_b64_tr_b16 v[82:83], v1 offset:8448
  ds_read_b64_tr_b16 v[84:85], v1 offset:10240
  ds_read_b64_tr_b16 v[86:87], v1 offset:10496
  ds_read_b64_tr_b16 v[88:89], v1 offset:12288
  ds_read_b64_tr_b16 v[90:91], v1 offset:12544
  ds_read_b64_tr_b16 v[92:93], v1 offset:32
  ds_read_b64_tr_b16 v[94:95], v1 offset:288
  ds_read_b64_tr_b16 v[96:97], v1 offset:2080
  ds_read_b64_tr_b16 v[98:99], v1 offset:2336
  ds_read_b64_tr_b16 v[100:101], v1 offset:4128
  ds_read_b64_tr_b16 v[102:103], v1 offset:4384
  ds_read_b64_tr_b16 v[104:105], v1 offset:6176
  ds_read_b64_tr_b16 v[106:107], v1 offset:6432
  ds_read_b64_tr_b16 v[108:109], v1 offset:8224
  ds_read_b64_tr_b16 v[110:111], v1 offset:8480
  ds_read_b64_tr_b16 v[112:113], v1 offset:10272
  ds_read_b64_tr_b16 v[114:115], v1 offset:10528
  ds_read_b64_tr_b16 v[116:117], v1 offset:12320
  ds_read_b64_tr_b16 v[118:119], v1 offset:12576
  v_lshlrev_b32 v23, 4, v0
  v_add_u32 v23, 104448, v23
  ds_read_b128 v[124:127], v23 offset:5120
  s_waitcnt lgkmcnt(0)
  s_branch L_r2_go
L_r2_skip:
  s_lshl_b32 s49, s28, 2
  s_lshl_b32 s56, 15, s49
  s_mov_b32 s57, s56
  s_mul_i32 s49, s28, 896
  s_lshl_b32 s51, s29, 5
  s_add_u32 s49, s49, s51
  v_and_b32 v16, 3, v0
  v_lshlrev_b32 v16, 3, v16
  v_lshrrev_b32 v23, 5, v0
  v_lshl_add_u32 v16, v23, 2, v16
  v_add_u32 v16, s49, v16
L_r2_go:
  s_sleep 4
  global_load_dwordx4 v[32:35], v24, s[40:41] offset:0 sc1
  global_load_dwordx4 v[36:39], v24, s[40:41] offset:1024 sc1
  global_load_dwordx4 v[40:43], v24, s[40:41] offset:2048 sc1
  global_load_dwordx4 v[44:47], v24, s[40:41] offset:3072 sc1
COMP_35:
  s_cmp_eq_u32 s31, 0
  s_waitcnt vmcnt(6)
  v_pk_add_f32 v[120:121], v[32:33], v[36:37]
  v_pk_add_f32 v[122:123], v[34:35], v[38:39]
  s_waitcnt vmcnt(5)
  v_pk_add_f32 v[120:121], v[120:121], v[40:41]
  v_pk_add_f32 v[122:123], v[122:123], v[42:43]
  s_waitcnt vmcnt(4)
  v_pk_add_f32 v[120:121], v[120:121], v[44:45]
  v_pk_add_f32 v[122:123], v[122:123], v[46:47]
  s_nop 1
  v_permlane32_swap_b32 v120, v122
  v_permlane32_swap_b32 v121, v123
  v_pk_add_f32 v[120:121], v[120:121], v[122:123]
  v_pk_add_f32 v[120:121], v[120:121], v[30:31]
  v_cvt_pk_bf16_f32 v122, v120, v121
  v_min_u32 v122, -2, v122
  v_cmp_u_f32 vcc, v120, v121
  s_cbranch_vccnz RETRY_36
OK_37:
  s_bitcmp1_b32 s32, 0
  s_cbranch_scc1 L_final
  s_cmp_eq_u32 s31, 0
  s_cbranch_scc1 SLOW_40
  global_store_dword v16, v122, s[42:43]
BACK_41:
  v_lshlrev_b32 v30, 16, v122
  v_and_b32 v31, 0xffff0000, v122
  v_add_f32 v120, v30, v31
  v_mul_f32 v121, v30, v30
  v_fmac_f32 v121, v31, v31
  s_nop 1
  v_permlane32_swap_b32 v120, v121
  v_add_f32 v120, v120, v121
  s_nop 1
  v_add_f32_dpp v120, v120, v120 quad_perm:[1,0,3,2] row_mask:0xf bank_mask:0xf
  s_nop 1
  v_add_f32_dpp v120, v120, v120 quad_perm:[2,3,0,1] row_mask:0xf bank_mask:0xf
  s_cbranch_scc1 SLOW_42
  s_mov_b64 exec, s[54:55]
  global_store_dword v17, v120, s[40:41] offset:2048
  s_mov_b64 exec, -1
BACK_43:
L_p1:
  s_cmp_eq_u32 s66, 0
  s_cbranch_scc1 NOBO_49
  s_sleep 2
NOBO_49:
  s_mov_b64 exec, s[56:57]
  global_load_dwordx4 v[4:7], v19, s[40:41] offset:2048 sc1
  global_load_dwordx4 v[8:11], v19, s[40:41] offset:3072 sc1
  s_mov_b64 exec, -1
  global_load_dwordx4 v[32:35], v27, s[42:43] offset:0 sc1
  global_load_dwordx4 v[36:39], v27, s[42:43] offset:512 sc1
  global_load_dwordx4 v[40:43], v27, s[42:43] offset:1024 sc1
  global_load_dwordx4 v[44:47], v27, s[42:43] offset:1536 sc1
  s_mov_b32 s64, 0
  s_sleep 4
  s_mov_b64 exec, s[56:57]
  global_load_dwordx4 v[4:7], v19, s[40:41] offset:2048 sc1
  global_load_dwordx4 v[8:11], v19, s[40:41] offset:3072 sc1
  s_mov_b64 exec, -1
  global_load_dwordx4 v[32:35], v27, s[42:43] offset:0 sc1
  global_load_dwordx4 v[36:39], v27, s[42:43] offset:512 sc1
  global_load_dwordx4 v[40:43], v27, s[42:43] offset:1024 sc1
  global_load_dwordx4 v[44:47], v27, s[42:43] offset:1536 sc1
COMP_44:
  s_waitcnt vmcnt(10)
  v_max3_u32 v2, v4, v5, v6
  v_max3_u32 v2, v7, v8, v2
  v_max3_u32 v2, v9, v10, v2
  v_max_u32 v2, v11, v2
  v_cmp_eq_u32 vcc, -1, v2
  s_cbranch_vccnz AGAIN_48
  s_cmp_eq_u32 s31, 0
  s_waitcnt vmcnt(9)
  v_mfma_f32_16x16x32_bf16 v[48:51], v[64:67], v[32:35], 0
  v_pk_add_f32 v[2:3], v[4:5], v[6:7]
  v_mfma_f32_16x16x32_bf16 v[56:59], v[92:95], v[32:35], 0
  v_pk_add_f32 v[2:3], v[2:3], v[8:9]
  s_waitcnt vmcnt(8)
  v_mfma_f32_16x16x32_bf16 v[48:51], v[68:71], v[36:39], v[48:51]
  v_pk_add_f32 v[2:3], v[2:3], v[10:11]
  v_mfma_f32_16x16x32_bf16 v[52:55], v[80:83], v[36:39], 0
  s_nop 0
  v_permlane32_swap_b32 v2, v3
  v_mfma_f32_16x16x32_bf16 v[56:59], v[96:99], v[36:39], v[56:59]
  v_add_f32 v2, v2, v3
  v_mfma_f32_16x16x32_bf16 v[60:63], v[108:111], v[36:39], 0
  v_mov_b32 v3, v2
  s_waitcnt vmcnt(7)
  v_mfma_f32_16x16x32_bf16 v[48:51], v[72:75], v[40:43], v[48:51]
  v_permlane16_swap_b32 v2, v3
  v_mfma_f32_16x16x32_bf16 v[52:55], v[84:87], v[40:43], v[52:55]
  v_add_f32 v2, v2, v3
  v_mfma_f32_16x16x32_bf16 v[56:59], v[100:103], v[40:43], v[56:59]
  s_nop 0
  v_add_f32_dpp v2, v2, v2 row_ror:8 row_mask:0xf bank_mask:0xf
  v_mfma_f32_16x16x32_bf16 v[60:63], v[112:115], v[40:43], v[60:63]
  v_mul_f32 v2, s61, v2
  s_waitcnt vmcnt(6)
  v_mfma_f32_16x16x32_bf16 v[48:51], v[76:79], v[44:47], v[48:51]
  v_mov_b32 v3, v2
  v_mfma_f32_16x16x32_bf16 v[52:55], v[88:91], v[44:47], v[52:55]
  s_nop 0
  v_permlane32_swap_b32 v2, v3
  v_mfma_f32_16x16x32_bf16 v[56:59], v[104:107], v[44:47], v[56:59]
  v_fma_f32 v3, -v2, v2, v3
  v_mfma_f32_16x16x32_bf16 v[60:63], v[116:119], v[44:47], v[60:63]
  v_add_f32 v3, s62, v3
  v_max_f32 v23, s62, v3
  v_rsq_f32 v23, v23
  s_nop 0
  v_fma_f32 v3, v3, 0, v23
  v_add_f32_dpp v120, v52, v48 row_ror:8 row_mask:0xf bank_mask:0x3
  v_add_f32_dpp v121, v53, v49 row_ror:8 row_mask:0xf bank_mask:0x3
  v_add_f32_dpp v122, v54, v50 row_ror:8 row_mask:0xf bank_mask:0x3
  v_add_f32_dpp v123, v55, v51 row_ror:8 row_mask:0xf bank_mask:0x3
  v_add_f32_dpp v120, v56, v60 row_ror:8 row_mask:0xf bank_mask:0xc
  v_add_f32_dpp v121, v57, v61 row_ror:8 row_mask:0xf bank_mask:0xc
  v_add_f32_dpp v122, v58, v62 row_ror:8 row_mask:0xf bank_mask:0xc
  v_add_f32_dpp v123, v59, v63 row_ror:8 row_mask:0xf bank_mask:0xc
  v_fma_f32 v120, -v2, v124, v120
  v_fma_f32 v121, -v2, v125, v121
  v_fma_f32 v122, -v2, v126, v122
  v_fma_f32 v123, -v2, v127, v123
  v_mul_f32 v120, v120, v3
  v_mul_f32 v121, v121, v3
  v_mul_f32 v122, v122, v3
  v_mul_f32 v123, v123, v3
  v_cvt_pk_bf16_f32 v48, v120, v121
  v_cvt_pk_bf16_f32 v49, v122, v123
  v_min_u32 v48, -2, v48
  v_min_u32 v49, -2, v49
  v_cmp_u_f32 vcc, v120, v120
  s_cbranch_vccnz RETRY_45
OK_46:
  s_cbranch_scc1 SLOW_50
  global_store_dwordx2 v25, v[48:49], s[26:27]
BACK_51:
  s_cmp_eq_u32 s66, 0
  s_cbranch_scc1 NOBO_52
  s_sleep 2
NOBO_52:
  global_load_dwordx4 v[92:95], v26, s[26:27] sc1
  global_load_dwordx4 v[96:99], v26, s[44:45] sc1
  s_waitcnt vmcnt(3)
  v_and_b32 v102, 15, v0
  v_lshrrev_b32 v103, 4, v0
  v_and_b32 v100, 1, v102
  v_lshlrev_b32 v100, 4, v100
  v_mov_b32 v101, 0xffff
  v_lshlrev_b32 v101, v100, v101
  v_bfe_u32 v100, v102, 1, 2
  v_cmp_eq_u32 vcc, 0, v100
  s_nop 1
  v_cndmask_b32 v4, 0, v101, vcc
  v_cmp_eq_u32 vcc, 1, v100
  s_nop 1
  v_cndmask_b32 v5, 0, v101, vcc
  v_cmp_eq_u32 vcc, 2, v100
  s_nop 1
  v_cndmask_b32 v6, 0, v101, vcc
  v_cmp_eq_u32 vcc, 3, v100
  s_nop 1
  v_cndmask_b32 v7, 0, v101, vcc
  v_lshrrev_b32 v100, 3, v102
  v_lshlrev_b32 v8, 9, v100
  v_bfe_u32 v101, v102, 2, 1
  v_lshl_add_u32 v8, v101, 10, v8
  v_lshl_add_u32 v8, v103, 4, v8
  v_add_u32 v8, 52224, v8
  v_lshrrev_b32 v101, 1, v103
  v_lshlrev_b32 v9, 10, v101
  v_lshl_add_u32 v9, v102, 5, v9
  v_and_b32 v101, 1, v103
  v_lshl_add_u32 v9, v101, 4, v9
  s_lshl_b32 s49, s30, 11
  s_add_u32 s49, s49, 54272
  v_add_u32 v9, s49, v9
  s_lshl_b32 s49, s30, 3
  s_add_u32 s49, s49, 70656
  v_lshlrev_b32 v10, 6, v100
  v_add_u32 v10, s49, v10
  s_mov_b32 s32, 1
  s_add_u32 s40, s26, 4194304
  s_addc_u32 s41, s27, 0
  v_lshlrev_b32 v100, 4, v0
  v_add_u32 v100, 52224, v100
L_bpoll:
  global_load_dwordx4 v[92:95], v26, s[26:27] sc1
  global_load_dwordx4 v[96:99], v26, s[44:45] sc1
  s_add_u32 s33, s33, 1
  s_cmp_gt_u32 s33, 400000
  s_cbranch_scc1 L_exit
L_bchk:
  s_waitcnt vmcnt(2)
  v_max3_u32 v2, v92, v93, v94
  v_max3_u32 v2, v95, v96, v2
  v_max3_u32 v2, v97, v98, v2
  v_max_u32 v2, v99, v2
  v_cmp_eq_u32 vcc, -1, v2
  s_cbranch_vccnz L_bpoll
  ds_write_b128 v100, v[92:95]
  ds_write_b128 v100, v[96:99] offset:1024
  s_waitcnt lgkmcnt(0)
  s_branch L_attn
L_final:
  s_mov_b64 exec, s[56:57]
  global_store_dword v16, v122, s[22:23]
  s_mov_b64 exec, -1
  s_cmp_eq_u32 s2, 0
  s_cbranch_scc0 L_noepoch
  v_mov_b32 v100, 1638400
  v_mov_b32 v101, s3
  s_mov_b64 exec, 1
  global_store_dword v100, v101, s[26:27]
  s_mov_b64 exec, -1
L_noepoch:
L_exit:
  s_endpgm
L_chain_pro:
  s_add_u32 s46, s26, 1638400
  s_addc_u32 s47, s27, 0
  s_load_dword s3, s[46:47], 0
  s_getreg_b32 s34, hwreg(HW_REG_XCC_ID, 0, 4)
  s_and_b32 s34, s34, 7
  s_mov_b32 s52, 0x00ff00ff
  s_mov_b32 s53, 0x00ff00ff
  s_mov_b32 s54, 0x11111111
  s_mov_b32 s55, 0x11111111
  s_mov_b32 s56, -1
  s_mov_b32 s57, 0x00ffffff
  s_mov_b32 s61, 0x3b124925
  s_mov_b32 s62, 0x3727c5ac
  s_mov_b32 s63, 0xbfb8aa3b
  s_mov_b32 s32, 0
  s_mov_b32 s33, 0
  s_mov_b32 s66, 0
  s_cmp_lt_u32 s29, 28
  s_cselect_b32 s67, s30, 0
  s_cmp_ge_u32 s29, 14
  s_cselect_b32 s37, 1, 0
  s_mul_i32 s49, s37, 14
  s_sub_u32 s38, s29, s49
  s_mov_b32 s60, 0x3db8aa3b
  s_lshr_b32 s36, s34, 2
  s_xor_b32 s36, s36, 0
  s_lshl_b32 s36, s36, 13
  s_mov_b64 s[40:41], s[26:27]
  s_add_u32 s44, s26, 16384
  s_addc_u32 s45, s27, 0
  s_add_u32 s42, s26, 16384
  s_addc_u32 s43, s27, 0
  s_lshr_b32 s49, s36, 13
  s_sub_u32 s49, 0x7fffffff, s49
  v_mov_b32 v100, 70784
  v_mov_b32 v102, 0x7fffffff
  v_mov_b32 v103, s49
  ds_write_b64 v100, v[102:103] offset:16
  v_and_b32 v102, 15, v0
  v_lshrrev_b32 v103, 4, v0
  v_lshrrev_b32 v100, 2, v102
  v_lshl_add_u32 v100, v103, 3, v100
  v_and_b32 v101, 3, v102
  v_lshlrev_b32 v1, 6, v100
  v_lshl_add_u32 v1, v101, 3, v1
  v_and_b32 v104, 7, v0
  v_mul_u32_u24 v104, 896, v104
  v_lshrrev_b32 v105, 3, v102
  v_mul_u32_u24 v105, 192, v105
  v_lshl_add_u32 v105, v103, 4, v105
  v_add_u32 v105, v105, v104
  s_and_b32 s49, s29, 1
  s_mul_i32 s49, s49, 448
  s_add_u32 s49, s49, 54272
  v_add_u32 v105, s49, v105
  v_lshrrev_b32 v106, 3, v0
  v_mul_u32_u24 v106, 112, v106
  v_add_u32 v106, v106, v104
  v_add_u32 v106, 54272, v106
  v_bfe_u32 v107, v0, 2, 3
  v_mul_u32_u24 v107, 896, v107
  v_and_b32 v108, 3, v0
  v_lshl_add_u32 v107, v108, 3, v107
  v_lshrrev_b32 v108, 5, v0
  v_lshl_add_u32 v107, v108, 2, v107
  s_min_u32 s49, s29, 27
  s_lshl_b32 s49, s49, 5
  s_add_u32 s49, s49, 54272
  v_add_u32 v107, s49, v107
  s_lshl_b32 s48, s28, 15
  s_add_u32 s48, s48, 1310720
  s_and_b32 s49, s29, 1
  s_lshl_b32 s49, s49, 14
  s_lshr_b32 s50, s29, 1
  s_lshl_b32 s50, s50, 7
  s_add_u32 s49, s49, s50
  s_add_u32 s49, s49, s48
  v_and_b32 v16, 7, v0
  v_lshlrev_b32 v16, 11, v16
  v_lshrrev_b32 v17, 3, v102
  v_lshl_add_u32 v16, v17, 6, v16
  v_lshl_add_u32 v16, v103, 4, v16
  v_add_u32 v16, s49, v16
  s_lshr_b32 s49, s29, 2
  s_lshl_b32 s49, s49, 11
  s_add_u32 s49, s49, s48
  v_lshlrev_b32 v18, 4, v0
  v_add_u32 v17, s49, v18
  v_add_u32 v18, 1572864, v18
  v_mov_b32 v19, 0
  v_mov_b32 v20, 0
  v_mov_b32 v120, 0x3f803f80
  v_mov_b32 v2, 0
  v_mov_b32 v3, 0
  s_waitcnt vmcnt(14) lgkmcnt(0)
  s_mul_i32 s3, s3, 0x9e3779b1
  s_add_u32 s3, s3, 0x7f4a7c15
  ds_read_b128 v[128:131], v106 offset:0
  ds_read_b128 v[132:135], v106 offset:16
  ds_read_b128 v[136:139], v106 offset:32
  ds_read_b128 v[140:143], v106 offset:48
  ds_read_b128 v[144:147], v106 offset:64
  ds_read_b128 v[148:151], v106 offset:80
  ds_read_b128 v[152:155], v106 offset:96
  ds_read_b128 v[32:35], v105 offset:0
  ds_read_b128 v[36:39], v105 offset:64
  ds_read_b128 v[40:43], v105 offset:128
  ds_read_b128 v[44:47], v105 offset:192
  ds_read_b32 v108, v107
  s_waitcnt lgkmcnt(0)
  v_dot2c_f32_bf16 v2, v128, v120
  v_dot2c_f32_bf16 v3, v128, v128
  v_dot2c_f32_bf16 v2, v129, v120
  v_dot2c_f32_bf16 v3, v129, v129
  v_dot2c_f32_bf16 v2, v130, v120
  v_dot2c_f32_bf16 v3, v130, v130
  v_dot2c_f32_bf16 v2, v131, v120
  v_dot2c_f32_bf16 v3, v131, v131
  v_dot2c_f32_bf16 v2, v132, v120
  v_dot2c_f32_bf16 v3, v132, v132
  v_dot2c_f32_bf16 v2, v133, v120
  v_dot2c_f32_bf16 v3, v133, v133
  v_dot2c_f32_bf16 v2, v134, v120
  v_dot2c_f32_bf16 v3, v134, v134
  v_dot2c_f32_bf16 v2, v135, v120
  v_dot2c_f32_bf16 v3, v135, v135
  v_dot2c_f32_bf16 v2, v136, v120
  v_dot2c_f32_bf16 v3, v136, v136
  v_dot2c_f32_bf16 v2, v137, v120
  v_dot2c_f32_bf16 v3, v137, v137
  v_dot2c_f32_bf16 v2, v138, v120
  v_dot2c_f32_bf16 v3, v138, v138
  v_dot2c_f32_bf16 v2, v139, v120
  v_dot2c_f32_bf16 v3, v139, v139
  v_dot2c_f32_bf16 v2, v140, v120
  v_dot2c_f32_bf16 v3, v140, v140
  v_dot2c_f32_bf16 v2, v141, v120
  v_dot2c_f32_bf16 v3, v141, v141
  v_dot2c_f32_bf16 v2, v142, v120
  v_dot2c_f32_bf16 v3, v142, v142
  v_dot2c_f32_bf16 v2, v143, v120
  v_dot2c_f32_bf16 v3, v143, v143
  v_dot2c_f32_bf16 v2, v144, v120
  v_dot2c_f32_bf16 v3, v144, v144
  v_dot2c_f32_bf16 v2, v145, v120
  v_dot2c_f32_bf16 v3, v145, v145
  v_dot2c_f32_bf16 v2, v146, v120
  v_dot2c_f32_bf16 v3, v146, v146
  v_dot2c_f32_bf16 v2, v147, v120
  v_dot2c_f32_bf16 v3, v147, v147
  v_dot2c_f32_bf16 v2, v148, v120
  v_dot2c_f32_bf16 v3, v148, v148
  v_dot2c_f32_bf16 v2, v149, v120
  v_dot2c_f32_bf16 v3, v149, v149
  v_dot2c_f32_bf16 v2, v150, v120
  v_dot2c_f32_bf16 v3, v150, v150
  v_dot2c_f32_bf16 v2, v151, v120
  v_dot2c_f32_bf16 v3, v151, v151
  v_dot2c_f32_bf16 v2, v152, v120
  v_dot2c_f32_bf16 v3, v152, v152
  v_dot2c_f32_bf16 v2, v153, v120
  v_dot2c_f32_bf16 v3, v153, v153
  v_dot2c_f32_bf16 v2, v154, v120
  v_dot2c_f32_bf16 v3, v154, v154
  v_dot2c_f32_bf16 v2, v155, v120
  v_dot2c_f32_bf16 v3, v155, v155
  v_lshlrev_b32 v30, 16, v108
  v_and_b32 v31, 0xffff0000, v108
  s_waitcnt vmcnt(0)
  ds_read_b64_tr_b16 v[64:65], v1 offset:0
  ds_read_b64_tr_b16 v[66:67], v1 offset:256
  ds_read_b64_tr_b16 v[68:69], v1 offset:2048
  ds_read_b64_tr_b16 v[70:71], v1 offset:2304
  ds_read_b64_tr_b16 v[72:73], v1 offset:4096
  ds_read_b64_tr_b16 v[74:75], v1 offset:4352
  ds_read_b64_tr_b16 v[76:77], v1 offset:6144
  ds_read_b64_tr_b16 v[78:79], v1 offset:6400
  ds_read_b64_tr_b16 v[80:81], v1 offset:8192
  ds_read_b64_tr_b16 v[82:83], v1 offset:8448
  ds_read_b64_tr_b16 v[84:85], v1 offset:10240
  ds_read_b64_tr_b16 v[86:87], v1 offset:10496
  ds_read_b64_tr_b16 v[88:89], v1 offset:12288
  ds_read_b64_tr_b16 v[90:91], v1 offset:12544
  ds_read_b64_tr_b16 v[92:93], v1 offset:32
  ds_read_b64_tr_b16 v[94:95], v1 offset:288
  ds_read_b64_tr_b16 v[96:97], v1 offset:2080
  ds_read_b64_tr_b16 v[98:99], v1 offset:2336
  ds_read_b64_tr_b16 v[100:101], v1 offset:4128
  ds_read_b64_tr_b16 v[102:103], v1 offset:4384
  ds_read_b64_tr_b16 v[104:105], v1 offset:6176
  ds_read_b64_tr_b16 v[106:107], v1 offset:6432
  ds_read_b64_tr_b16 v[108:109], v1 offset:8224
  ds_read_b64_tr_b16 v[110:111], v1 offset:8480
  ds_read_b64_tr_b16 v[112:113], v1 offset:10272
  ds_read_b64_tr_b16 v[114:115], v1 offset:10528
  ds_read_b64_tr_b16 v[116:117], v1 offset:12320
  ds_read_b64_tr_b16 v[118:119], v1 offset:12576
  v_lshlrev_b32 v23, 4, v0
  v_add_u32 v23, 104448, v23
  v_mov_b32 v120, 0x3f803f80
  v_mov_b32 v121, 0x3f803f80
  v_mov_b32 v122, 0x3f803f80
  v_mov_b32 v123, 0x3f803f80
  s_waitcnt lgkmcnt(0)
  s_nop 0
  v_mfma_f32_16x16x32_bf16 v[124:127], v[64:67], v[120:123], 0
  v_mfma_f32_16x16x32_bf16 v[60:63], v[92:95], v[120:123], 0
  v_mfma_f32_16x16x32_bf16 v[124:127], v[68:71], v[120:123], v[124:127]
  v_mfma_f32_16x16x32_bf16 v[60:63], v[96:99], v[120:123], v[60:63]
  v_mfma_f32_16x16x32_bf16 v[124:127], v[72:75], v[120:123], v[124:127]
  v_mfma_f32_16x16x32_bf16 v[60:63], v[100:103], v[120:123], v[60:63]
  v_mfma_f32_16x16x32_bf16 v[124:127], v[76:79], v[120:123], v[124:127]
  v_mfma_f32_16x16x32_bf16 v[60:63], v[104:107], v[120:123], v[60:63]
  v_mfma_f32_16x16x32_bf16 v[124:127], v[80:83], v[120:123], v[124:127]
  v_mfma_f32_16x16x32_bf16 v[60:63], v[108:111], v[120:123], v[60:63]
  v_mfma_f32_16x16x32_bf16 v[124:127], v[84:87], v[120:123], v[124:127]
  v_mfma_f32_16x16x32_bf16 v[60:63], v[112:115], v[120:123], v[60:63]
  v_mfma_f32_16x16x32_bf16 v[124:127], v[88:91], v[120:123], v[124:127]
  v_mfma_f32_16x16x32_bf16 v[60:63], v[116:119], v[120:123], v[60:63]
  s_nop 7
  v_cndmask_b32 v124, v60, v124, s[52:53]
  v_cndmask_b32 v125, v61, v125, s[52:53]
  v_cndmask_b32 v126, v62, v126, s[52:53]
  v_cndmask_b32 v127, v63, v127, s[52:53]
  ds_write_b128 v23, v[124:127] offset:5120
  v_mfma_f32_16x16x32_bf16 v[48:51], v[64:67], v[32:35], 0
  v_permlane32_swap_b32 v2, v3
  v_mfma_f32_16x16x32_bf16 v[56:59], v[92:95], v[32:35], 0
  v_add_f32 v2, v2, v3
  v_mfma_f32_16x16x32_bf16 v[48:51], v[68:71], v[36:39], v[48:51]
  v_mov_b32 v3, v2
  v_mfma_f32_16x16x32_bf16 v[52:55], v[80:83], v[36:39], 0
  s_nop 0
  v_permlane16_swap_b32 v2, v3
  v_mfma_f32_16x16x32_bf16 v[56:59], v[96:99], v[36:39], v[56:59]
  v_add_f32 v2, v2, v3
  v_mfma_f32_16x16x32_bf16 v[60:63], v[108:111], v[36:39], 0
  s_nop 0
  v_add_f32_dpp v2, v2, v2 row_ror:8 row_mask:0xf bank_mask:0xf
  v_mfma_f32_16x16x32_bf16 v[48:51], v[72:75], v[40:43], v[48:51]
  v_mul_f32 v2, s61, v2
  v_mfma_f32_16x16x32_bf16 v[52:55], v[84:87], v[40:43], v[52:55]
  v_mov_b32 v3, v2
  v_mfma_f32_16x16x32_bf16 v[56:59], v[100:103], v[40:43], v[56:59]
  s_nop 0
  v_permlane32_swap_b32 v2, v3
  v_mfma_f32_16x16x32_bf16 v[60:63], v[112:115], v[40:43], v[60:63]
  v_fma_f32 v3, -v2, v2, v3
  v_mfma_f32_16x16x32_bf16 v[48:51], v[76:79], v[44:47], v[48:51]
  v_add_f32 v3, s62, v3
  v_mfma_f32_16x16x32_bf16 v[52:55], v[88:91], v[44:47], v[52:55]
  v_max_f32 v23, s62, v3
  v_mfma_f32_16x16x32_bf16 v[56:59], v[104:107], v[44:47], v[56:59]
  v_rsq_f32 v23, v23
  v_mfma_f32_16x16x32_bf16 v[60:63], v[116:119], v[44:47], v[60:63]
  v_fma_f32 v3, v3, 0, v23
  s_nop 2
  v_add_f32_dpp v120, v52, v48 row_ror:8 row_mask:0xf bank_mask:0x3
  v_add_f32_dpp v121, v53, v49 row_ror:8 row_mask:0xf bank_mask:0x3
  v_add_f32_dpp v122, v54, v50 row_ror:8 row_mask:0xf bank_mask:0x3
  v_add_f32_dpp v123, v55, v51 row_ror:8 row_mask:0xf bank_mask:0x3
  v_add_f32_dpp v120, v56, v60 row_ror:8 row_mask:0xf bank_mask:0xc
  v_add_f32_dpp v121, v57, v61 row_ror:8 row_mask:0xf bank_mask:0xc
  v_add_f32_dpp v122, v58, v62 row_ror:8 row_mask:0xf bank_mask:0xc
  v_add_f32_dpp v123, v59, v63 row_ror:8 row_mask:0xf bank_mask:0xc
  v_fma_f32 v120, -v2, v124, v120
  v_fma_f32 v121, -v2, v125, v121
  v_fma_f32 v122, -v2, v126, v122
  v_fma_f32 v123, -v2, v127, v123
  v_mul_f32 v120, v120, v3
  v_mul_f32 v121, v121, v3
  v_mul_f32 v122, v122, v3
  v_mul_f32 v123, v123, v3
  v_cvt_pk_bf16_f32 v48, v120, v121
  v_cvt_pk_bf16_f32 v50, v122, v123
  v_mov_b32 v49, s3
  v_mov_b32 v51, s3
  global_store_dwordx4 v16, v[48:51], s[26:27] sc1
  v_and_b32 v102, 15, v0
  v_lshrrev_b32 v103, 4, v0
  v_and_b32 v100, 1, v102
  v_lshlrev_b32 v100, 4, v100
  v_mov_b32 v101, 0xffff
  v_lshlrev_b32 v101, v100, v101
  v_bfe_u32 v100, v102, 1, 2
  v_cmp_eq_u32 vcc, 0, v100
  s_nop 1
  v_cndmask_b32 v4, 0, v101, vcc
  v_cmp_eq_u32 vcc, 1, v100
  s_nop 1
  v_cndmask_b32 v5, 0, v101, vcc
  v_cmp_eq_u32 vcc, 2, v100
  s_nop 1
  v_cndmask_b32 v6, 0, v101, vcc
  v_cmp_eq_u32 vcc, 3, v100
  s_nop 1
  v_cndmask_b32 v7, 0, v101, vcc
  v_lshrrev_b32 v100, 3, v102
  v_lshlrev_b32 v8, 9, v100
  v_bfe_u32 v101, v102, 2, 1
  v_lshl_add_u32 v8, v101, 10, v8
  v_lshl_add_u32 v8, v103, 4, v8
  v_add_u32 v8, 52224, v8
  v_lshrrev_b32 v101, 1, v103
  v_lshlrev_b32 v9, 10, v101
  v_lshl_add_u32 v9, v102, 5, v9
  v_and_b32 v101, 1, v103
  v_lshl_add_u32 v9, v101, 4, v9
  s_lshl_b32 s49, s30, 11
  s_add_u32 s49, s49, 54272
  v_add_u32 v9, s49, v9
  s_lshl_b32 s49, s30, 3
  s_add_u32 s49, s49, 70656
  v_lshlrev_b32 v10, 6, v100
  v_add_u32 v10, s49, v10
  v_lshlrev_b32 v100, 3, v0
  v_add_u32 v100, 52224, v100
  v_mov_b32 v104, 70784
  s_mov_b32 s64, s29
L_trig:
  ds_read_b32 v105, v104 offset:8
  s_add_u32 s33, s33, 1
  s_cmp_gt_u32 s33, 400000
  s_cbranch_scc1 L_exit
  s_waitcnt lgkmcnt(0)
  v_readfirstlane_b32 s49, v105
  s_cmp_eq_u32 s49, 0
  s_cbranch_scc0 L_q1poll
  s_sleep 4
  s_branch L_trig
L_q1poll:
  global_load_dwordx4 v[32:35], v17, s[26:27] sc1
  global_load_dwordx4 v[36:39], v17, s[26:27] offset:1024 sc1
  global_load_dwordx4 v[40:43], v17, s[44:45] sc1
  global_load_dwordx4 v[44:47], v17, s[44:45] offset:1024 sc1
  global_load_dwordx4 v[48:51], v18, s[26:27] sc1
  global_load_dwordx4 v[52:55], v18, s[26:27] offset:1024 sc1
  s_add_u32 s33, s33, 1
  s_cmp_gt_u32 s33, 400000
  s_cbranch_scc1 L_exit
  s_waitcnt vmcnt(0)
L_q1w:
  v_xor_b32 v33, s3, v33
  v_xor_b32 v35, s3, v35
  v_xor_b32 v37, s3, v37
  v_xor_b32 v39, s3, v39
  v_xor_b32 v41, s3, v41
  v_xor_b32 v43, s3, v43
  v_xor_b32 v45, s3, v45
  v_xor_b32 v47, s3, v47
  v_xor_b32 v49, s3, v49
  v_xor_b32 v51, s3, v51
  v_xor_b32 v53, s3, v53
  v_xor_b32 v55, s3, v55
  v_or3_b32 v2, v33, v35, v37
  v_or3_b32 v2, v39, v41, v2
  v_or3_b32 v2, v43, v45, v2
  v_or3_b32 v2, v47, v49, v2
  v_or3_b32 v2, v51, v53, v2
  v_or_b32 v2, v2, v55
  v_cmp_ne_u32 vcc, 0, v2
  s_cbranch_vccnz L_q1poll
  v_mov_b32 v33, v34
  ds_write_b64 v100, v[32:33] offset:0
  v_mov_b32 v37, v38
  ds_write_b64 v100, v[36:37] offset:512
  v_mov_b32 v41, v42
  ds_write_b64 v100, v[40:41] offset:1024
  v_mov_b32 v45, v46
  ds_write_b64 v100, v[44:45] offset:1536
  v_lshl_or_b32 v48, v50, 4, v48
  v_lshl_or_b32 v52, v54, 4, v52
  s_mov_b32 s49, 0
  s_mov_b32 s50, 0
  v_readlane_b32 s48, v48, 0
  s_lshl_b32 s51, s48, 0
  s_or_b32 s49, s49, s51
  s_and_b32 s51, s48, 7
  s_bitset1_b32 s50, s51
  s_lshr_b32 s51, s48, 4
  s_bitset1_b32 s50, s51
  v_readlane_b32 s48, v48, 1
  s_lshl_b32 s51, s48, 8
  s_or_b32 s49, s49, s51
  s_and_b32 s51, s48, 7
  s_bitset1_b32 s50, s51
  s_lshr_b32 s51, s48, 4
  s_bitset1_b32 s50, s51
  v_readlane_b32 s48, v48, 2
  s_lshl_b32 s51, s48, 16
  s_or_b32 s49, s49, s51
  s_and_b32 s51, s48, 7
  s_bitset1_b32 s50, s51
  s_lshr_b32 s51, s48, 4
  s_bitset1_b32 s50, s51
  v_readlane_b32 s48, v48, 3
  s_lshl_b32 s51, s48, 24
  s_or_b32 s49, s49, s51
  s_and_b32 s51, s48, 7
  s_bitset1_b32 s50, s51
  s_lshr_b32 s51, s48, 4
  s_bitset1_b32 s50, s51
  v_and_b32 v49, 3, v0
  v_lshlrev_b32 v49, 3, v49
  v_lshrrev_b32 v49, v49, s49
  v_and_b32 v49, 0xff, v49
  v_xor_b32 v48, v48, v49
  v_xor_b32 v52, v52, v49
  v_or_b32 v48, v48, v52
  v_cmp_ne_u32 vcc, 0, v48
  s_cmp_eq_u32 s50, 0xff
  s_cselect_b32 s31, 1, 0
  s_cmp_eq_u64 vcc, 0
  s_cselect_b32 s31, s31, 0
  v_mov_b32 v105, s31
  ds_write_b32 v104, v105
  s_cmp_eq_u32 s31, 0
  s_cselect_b32 s39, s28, s34
  s_lshr_b32 s35, s39, 2
  s_xor_b32 s35, s35, 0
  s_lshl_b32 s35, s35, 13
  s_and_b32 s39, s39, 3
  s_mul_i32 s65, s39, 49152
  s_add_u32 s65, s65, s35
  s_add_u32 s65, s65, 393216
  v_and_b32 v102, 15, v0
  v_lshrrev_b32 v103, 4, v0
  v_lshrrev_b32 v100, 2, v102
  v_lshl_add_u32 v100, v103, 3, v100
  v_and_b32 v101, 3, v102
  v_lshlrev_b32 v1, 6, v100
  v_lshl_add_u32 v1, v101, 3, v1
  s_lshl_b32 s50, s39, 1
  s_add_u32 s50, s50, s37
  s_lshl_b32 s50, s50, 1
  s_add_u32 s50, s50, s30
  s_lshl_b32 s50, s50, 14
  s_add_u32 s50, s50, s35
  s_add_u32 s50, s50, 135168
  v_lshlrev_b32 v13, 4, v0
  v_add_u32 v13, s50, v13
  s_lshl_b32 s49, s37, 8
  s_lshl_b32 s50, s30, 7
  s_add_u32 s49, s49, s50
  s_add_u32 s49, s49, s65
  s_add_u32 s49, s49, 7168
  v_lshlrev_b32 v14, 3, v102
  v_add_u32 v14, s49, v14
  s_lshl_b32 s49, s38, 15
  s_lshl_b32 s50, s28, 1
  s_add_u32 s50, s50, s37
  s_lshl_b32 s50, s50, 9
  s_add_u32 s49, s49, s50
  s_lshl_b32 s50, s30, 8
  s_add_u32 s49, s49, s50
  s_add_u32 s49, s49, 589824
  v_and_b32 v100, 1, v102
  v_lshlrev_b32 v15, 14, v100
  v_bfe_u32 v100, v102, 1, 1
  v_lshl_add_u32 v15, v100, 13, v15
  v_lshrrev_b32 v100, 2, v102
  v_lshl_add_u32 v15, v100, 6, v15
  v_lshl_add_u32 v15, v103, 4, v15
  v_add_u32 v15, s49, v15
  s_lshl_b32 s49, s29, 14
  s_add_u32 s49, s49, s36
  s_add_u32 s49, s49, 593920
  v_lshlrev_b32 v12, 4, v0
  v_add_u32 v12, s49, v12
  s_mov_b32 s58, 0xaaaaaaaa
  s_mov_b32 s59, 0xaaaaaaaa
  v_lshlrev_b32 v100, 4, v0
  v_add_u32 v100, 71680, v100
  s_lshl_b32 s49, s28, 1
  s_add_u32 s49, s49, s37
  s_mul_i32 s49, s49, 229376
  s_lshl_b32 s50, s38, 6
  s_add_u32 s49, s49, s50
  v_lshrrev_b32 v96, 2, v0
  v_mul_u32_u24 v96, 896, v96
  v_and_b32 v97, 3, v0
  v_lshl_add_u32 v96, v97, 4, v96
  v_add_u32 v96, s49, v96
  s_waitcnt lgkmcnt(0)
  s_barrier
  s_cmp_lt_u32 s29, 28
  s_cbranch_scc0 L_nolate
  s_mov_b32 m0, 14336
  s_nop 0
  global_load_lds_dwordx4 v96, s[12:13] nt
  v_add_u32 v96, 14336, v96
  s_mov_b32 m0, 15360
  s_nop 0
  global_load_lds_dwordx4 v96, s[12:13] nt
  v_add_u32 v96, 14336, v96
  s_mov_b32 m0, 16384
  s_nop 0
  global_load_lds_dwordx4 v96, s[12:13] nt
  v_add_u32 v96, 14336, v96
  s_mov_b32 m0, 17408
  s_nop 0
  global_load_lds_dwordx4 v96, s[12:13] nt
  v_add_u32 v96, 14336, v96
  s_mov_b32 m0, 18432
  s_nop 0
  global_load_lds_dwordx4 v96, s[12:13] nt
  v_add_u32 v96, 14336, v96
  s_mov_b32 m0, 19456
  s_nop 0
  global_load_lds_dwordx4 v96, s[12:13] nt
  v_add_u32 v96, 14336, v96
  s_mov_b32 m0, 20480
  s_nop 0
  global_load_lds_dwordx4 v96, s[12:13] nt
  v_add_u32 v96, 14336, v96
  s_mov_b32 m0, 21504
  s_nop 0
  global_load_lds_dwordx4 v96, s[12:13] nt
  v_add_u32 v96, 14336, v96
  s_mov_b32 m0, 22528
  s_nop 0
  global_load_lds_dwordx4 v96, s[12:13] nt
  v_add_u32 v96, 14336, v96
  s_mov_b32 m0, 23552
  s_nop 0
  global_load_lds_dwordx4 v96, s[12:13] nt
  v_add_u32 v96, 14336, v96
  s_mov_b32 m0, 24576
  s_nop 0
  global_load_lds_dwordx4 v96, s[12:13] nt
  v_add_u32 v96, 14336, v96
  s_mov_b32 m0, 25600
  s_nop 0
  global_load_lds_dwordx4 v96, s[12:13] nt
  v_add_u32 v96, 14336, v96
  s_mov_b32 m0, 26624
  s_nop 0
  global_load_lds_dwordx4 v96, s[12:13] nt
  v_add_u32 v96, 14336, v96
  s_mov_b32 m0, 27648
  s_nop 0
  global_load_lds_dwordx4 v96, s[12:13] nt
  v_add_u32 v96, 14336, v96
  s_mov_b32 m0, 28672
  s_nop 0
  global_load_lds_dwordx4 v96, s[12:13] nt
  v_add_u32 v96, 14336, v96
  s_mov_b32 m0, 29696
  s_nop 0
  global_load_lds_dwordx4 v96, s[12:13] nt
  s_mul_i32 s49, s28, 448
  s_and_b32 s49, s49, 0xffffff80
  s_mul_i32 s50, s29, 57344
  s_add_u32 s49, s49, s50
  v_lshrrev_b32 v96, 2, v0
  v_mul_u32_u24 v96, 3584, v96
  v_and_b32 v97, 3, v0
  v_lshl_add_u32 v96, v97, 7, v96
  v_add_u32 v96, s49, v96
  global_load_dword v3, v96, s[16:17]
  global_load_dword v3, v96, s[18:19]
  s_mul_i32 s49, s28, 200704
  s_mul_i32 s50, s29, 7168
  s_add_u32 s49, s49, s50
  v_min_u32 v97, 55, v0
  v_lshlrev_b32 v97, 7, v97
  v_add_u32 v97, s49, v97
  global_load_dword v3, v97, s[20:21]
L_nolate:
  ds_read_b128 v[128:131], v100 offset:0
  ds_read_b128 v[132:135], v100 offset:1024
  ds_read_b128 v[136:139], v100 offset:2048
  ds_read_b128 v[140:143], v100 offset:3072
  ds_read_b128 v[144:147], v100 offset:4096
  ds_read_b128 v[148:151], v100 offset:5120
  ds_read_b128 v[152:155], v100 offset:6144
  ds_read_b128 v[156:159], v100 offset:7168
  s_waitcnt lgkmcnt(4)
  ds_read_b128 v[160:163], v100 offset:8192
  ds_read_b128 v[164:167], v100 offset:9216
  ds_read_b128 v[168:171], v100 offset:10240
  ds_read_b128 v[172:175], v100 offset:11264
  ds_read_b128 v[176:179], v100 offset:12288
  ds_read_b128 v[180:183], v100 offset:13312
  ds_read_b128 v[184:187], v100 offset:14336
  ds_read_b128 v[188:191], v100 offset:15360
  s_waitcnt lgkmcnt(4)
  ds_read_b128 v[192:195], v100 offset:16384
  ds_read_b128 v[196:199], v100 offset:17408
  ds_read_b128 v[200:203], v100 offset:18432
  ds_read_b128 v[204:207], v100 offset:19456
  ds_read_b128 v[208:211], v100 offset:20480
  ds_read_b128 v[212:215], v100 offset:21504
  ds_read_b128 v[216:219], v100 offset:22528
  ds_read_b128 v[220:223], v100 offset:23552
  s_waitcnt lgkmcnt(4)
  ds_read_b128 v[224:227], v100 offset:24576
  ds_read_b128 v[228:231], v100 offset:25600
  ds_read_b128 v[232:235], v100 offset:26624
  ds_read_b128 v[236:239], v100 offset:27648
  ds_read_b128 v[240:243], v100 offset:28672
  ds_read_b128 v[244:247], v100 offset:29696
  ds_read_b128 v[248:251], v100 offset:30720
  ds_read_b128 v[252:255], v100 offset:31744
  s_waitcnt lgkmcnt(4)
  s_waitcnt lgkmcnt(0)
  s_branch L_attn2
SLOW_1:
  global_store_dword v18, v92, s[40:41] sc1
  s_branch BACK_2
SLOW_3:
  s_mov_b64 exec, 1
  global_store_dwordx2 v19, v[88:89], s[40:41] sc1
  s_mov_b64 exec, -1
  s_branch BACK_4
AGAIN_9:
  s_waitcnt vmcnt(9)
  global_load_dwordx2 v[2:3], v14, s[40:41] sc1
  global_load_dwordx4 v[32:35], v13, s[40:41] offset:-4096 sc1
  global_load_dwordx4 v[36:39], v13, s[40:41] offset:-3072 sc1
  global_load_dwordx4 v[40:43], v13, s[40:41] offset:-2048 sc1
  global_load_dwordx4 v[44:47], v13, s[40:41] offset:-1024 sc1
  global_load_dwordx4 v[48:51], v13, s[40:41] offset:0 sc1
  global_load_dwordx4 v[52:55], v13, s[40:41] offset:1024 sc1
  global_load_dwordx4 v[56:59], v13, s[40:41] offset:2048 sc1
  global_load_dwordx4 v[60:63], v13, s[40:41] offset:3072 sc1
  s_add_u32 s33, s33, 1
  s_cmp_gt_u32 s33, 400000
  s_cbranch_scc1 L_exit
  s_branch COMP_5
RETRY_6:
  s_cmp_eq_u32 s64, 0
  s_cbranch_scc1 POLL_8
  s_cmp_eq_u32 s31, 0
  s_branch OK_7
POLL_8:
  global_load_dwordx2 v[2:3], v14, s[40:41] sc1
  global_load_dwordx4 v[32:35], v13, s[40:41] offset:-4096 sc1
  global_load_dwordx4 v[36:39], v13, s[40:41] offset:-3072 sc1
  global_load_dwordx4 v[40:43], v13, s[40:41] offset:-2048 sc1
  global_load_dwordx4 v[44:47], v13, s[40:41] offset:-1024 sc1
  global_load_dwordx4 v[48:51], v13, s[40:41] offset:0 sc1
  global_load_dwordx4 v[52:55], v13, s[40:41] offset:1024 sc1
  global_load_dwordx4 v[56:59], v13, s[40:41] offset:2048 sc1
  global_load_dwordx4 v[60:63], v13, s[40:41] offset:3072 sc1
  s_add_u32 s33, s33, 1
  s_cmp_gt_u32 s33, 400000
  s_cbranch_scc1 L_exit
  v_max3_u32 v26, v2, v3, v32
  v_max3_u32 v26, v33, v34, v26
  v_max3_u32 v26, v35, v36, v26
  v_max3_u32 v26, v37, v38, v26
  v_max3_u32 v26, v39, v40, v26
  v_max3_u32 v26, v41, v42, v26
  v_max3_u32 v26, v43, v44, v26
  v_max3_u32 v26, v45, v46, v26
  v_max3_u32 v26, v47, v48, v26
  v_max3_u32 v26, v49, v50, v26
  v_max3_u32 v26, v51, v52, v26
  v_max3_u32 v26, v53, v54, v26
  v_max3_u32 v26, v55, v56, v26
  v_max3_u32 v26, v57, v58, v26
  v_max3_u32 v26, v59, v60, v26
  v_max3_u32 v26, v61, v62, v26
  v_max_u32 v26, v63, v26
  v_cmp_eq_u32 vcc, -1, v26
  s_cbranch_vccnz COMP_5
  s_mov_b32 s64, 1
  s_branch COMP_5
RETRY_13:
  s_cmp_eq_u32 s64, 0
  s_cbranch_scc1 POLL_15
  s_cmp_eq_u32 s31, 0
  s_branch OK_14
POLL_15:
  global_load_dwordx4 v[32:35], v12, s[40:41] offset:-4096 sc1
  global_load_dwordx4 v[36:39], v12, s[40:41] offset:-3072 sc1
  global_load_dwordx4 v[40:43], v12, s[40:41] offset:-2048 sc1
  global_load_dwordx4 v[44:47], v12, s[40:41] offset:-1024 sc1
  global_load_dwordx4 v[48:51], v12, s[40:41] offset:0 sc1
  global_load_dwordx4 v[52:55], v12, s[40:41] offset:1024 sc1
  global_load_dwordx4 v[56:59], v12, s[40:41] offset:2048 sc1
  global_load_dwordx4 v[60:63], v12, s[40:41] offset:3072 sc1
  s_add_u32 s33, s33, 1
  s_cmp_gt_u32 s33, 400000
  s_cbranch_scc1 L_exit
  v_max3_u32 v120, v32, v33, v34
  v_max3_u32 v120, v35, v36, v120
  v_max3_u32 v120, v37, v38, v120
  v_max3_u32 v120, v39, v40, v120
  v_max3_u32 v120, v41, v42, v120
  v_max3_u32 v120, v43, v44, v120
  v_max3_u32 v120, v45, v46, v120
  v_max3_u32 v120, v47, v48, v120
  v_max3_u32 v120, v49, v50, v120
  v_max3_u32 v120, v51, v52, v120
  v_max3_u32 v120, v53, v54, v120
  v_max3_u32 v120, v55, v56, v120
  v_max3_u32 v120, v57, v58, v120
  v_max3_u32 v120, v59, v60, v120
  v_max3_u32 v120, v61, v62, v120
  v_max_u32 v120, v63, v120
  v_cmp_eq_u32 vcc, -1, v120
  s_cbranch_vccnz COMP_12
  s_mov_b32 s64, 1
  s_branch COMP_12
SLOW_17:
  global_store_dword v16, v122, s[40:41] sc1
  s_branch BACK_18
SLOW_19:
  s_mov_b64 exec, s[54:55]
  global_store_dword v17, v120, s[40:41] offset:0 sc1
  s_mov_b64 exec, -1
  s_branch BACK_20
AGAIN_25:
  s_waitcnt vmcnt(9)
  s_mov_b64 exec, s[56:57]
  global_load_dwordx4 v[4:7], v19, s[40:41] offset:0 sc1
  global_load_dwordx4 v[8:11], v19, s[40:41] offset:1024 sc1
  s_mov_b64 exec, -1
  global_load_dwordx4 v[32:35], v18, s[40:41] offset:0 sc1
  global_load_dwordx4 v[36:39], v18, s[40:41] offset:512 sc1
  global_load_dwordx4 v[40:43], v18, s[40:41] offset:1024 sc1
  global_load_dwordx4 v[44:47], v18, s[40:41] offset:1536 sc1
  global_load_dwordx4 v[48:51], v18, s[40:41] offset:2048 sc1
  global_load_dwordx4 v[52:55], v18, s[40:41] offset:2560 sc1
  global_load_dwordx4 v[56:59], v18, s[40:41] offset:3072 sc1
  s_add_u32 s33, s33, 1
  s_cmp_gt_u32 s33, 400000
  s_cbranch_scc1 L_exit
  s_branch COMP_21
RETRY_22:
  s_cmp_eq_u32 s64, 0
  s_cbranch_scc1 POLL_24
  s_cmp_eq_u32 s31, 0
  s_branch OK_23
POLL_24:
  s_mov_b64 exec, s[56:57]
  global_load_dwordx4 v[4:7], v19, s[40:41] offset:0 sc1
  global_load_dwordx4 v[8:11], v19, s[40:41] offset:1024 sc1
  s_mov_b64 exec, -1
  global_load_dwordx4 v[32:35], v18, s[40:41] offset:0 sc1
  global_load_dwordx4 v[36:39], v18, s[40:41] offset:512 sc1
  global_load_dwordx4 v[40:43], v18, s[40:41] offset:1024 sc1
  global_load_dwordx4 v[44:47], v18, s[40:41] offset:1536 sc1
  global_load_dwordx4 v[48:51], v18, s[40:41] offset:2048 sc1
  global_load_dwordx4 v[52:55], v18, s[40:41] offset:2560 sc1
  global_load_dwordx4 v[56:59], v18, s[40:41] offset:3072 sc1
  s_add_u32 s33, s33, 1
  s_cmp_gt_u32 s33, 400000
  s_cbranch_scc1 L_exit
  v_max3_u32 v2, v32, v33, v34
  v_max3_u32 v2, v35, v36, v2
  v_max3_u32 v2, v37, v38, v2
  v_max3_u32 v2, v39, v40, v2
  v_max3_u32 v2, v41, v42, v2
  v_max3_u32 v2, v43, v44, v2
  v_max3_u32 v2, v45, v46, v2
  v_max3_u32 v2, v47, v48, v2
  v_max3_u32 v2, v49, v50, v2
  v_max3_u32 v2, v51, v52, v2
  v_max3_u32 v2, v53, v54, v2
  v_max3_u32 v2, v55, v56, v2
  v_max3_u32 v2, v57, v58, v2
  v_max3_u32 v2, v59, v4, v2
  v_max3_u32 v2, v5, v6, v2
  v_max3_u32 v2, v7, v8, v2
  v_max3_u32 v2, v9, v10, v2
  v_max_u32 v2, v11, v2
  v_cmp_eq_u32 vcc, -1, v2
  s_cbranch_vccnz COMP_21
  s_mov_b32 s64, 1
  s_branch COMP_21
SLOW_27:
  s_mov_b64 exec, s[52:53]
  global_store_dword v20, v62, s[40:41] sc1
  s_mov_b64 exec, -1
  s_branch BACK_28
RETRY_30:
  s_cmp_eq_u32 s64, 0
  s_cbranch_scc1 POLL_32
  s_cmp_eq_u32 s31, 0
  s_branch OK_31
POLL_32:
  global_load_dwordx4 v[32:35], v21, s[40:41] offset:0 sc1
  global_load_dwordx4 v[36:39], v21, s[40:41] offset:512 sc1
  global_load_dwordx4 v[40:43], v21, s[40:41] offset:1024 sc1
  global_load_dwordx4 v[44:47], v21, s[40:41] offset:1536 sc1
  s_add_u32 s33, s33, 1
  s_cmp_gt_u32 s33, 400000
  s_cbranch_scc1 L_exit
  v_max3_u32 v2, v32, v33, v34
  v_max3_u32 v2, v35, v36, v2
  v_max3_u32 v2, v37, v38, v2
  v_max3_u32 v2, v39, v40, v2
  v_max3_u32 v2, v41, v42, v2
  v_max3_u32 v2, v43, v44, v2
  v_max3_u32 v2, v45, v46, v2
  v_max_u32 v2, v47, v2
  v_cmp_eq_u32 vcc, -1, v2
  s_cbranch_vccnz COMP_29
  s_mov_b32 s64, 1
  s_branch COMP_29
RETRY_36:
  s_cmp_eq_u32 s64, 0
  s_cbranch_scc1 POLL_38
  s_cmp_eq_u32 s31, 0
  s_branch OK_37
POLL_38:
  global_load_dwordx4 v[32:35], v24, s[40:41] offset:0 sc1
  global_load_dwordx4 v[36:39], v24, s[40:41] offset:1024 sc1
  global_load_dwordx4 v[40:43], v24, s[40:41] offset:2048 sc1
  global_load_dwordx4 v[44:47], v24, s[40:41] offset:3072 sc1
  s_add_u32 s33, s33, 1
  s_cmp_gt_u32 s33, 400000
  s_cbranch_scc1 L_exit
  v_max3_u32 v120, v32, v33, v34
  v_max3_u32 v120, v35, v36, v120
  v_max3_u32 v120, v37, v38, v120
  v_max3_u32 v120, v39, v40, v120
  v_max3_u32 v120, v41, v42, v120
  v_max3_u32 v120, v43, v44, v120
  v_max3_u32 v120, v45, v46, v120
  v_max_u32 v120, v47, v120
  v_cmp_eq_u32 vcc, -1, v120
  s_cbranch_vccnz COMP_35
  s_mov_b32 s64, 1
  s_branch COMP_35
SLOW_40:
  global_store_dword v16, v122, s[42:43] sc1
  s_branch BACK_41
SLOW_42:
  s_mov_b64 exec, s[54:55]
  global_store_dword v17, v120, s[40:41] offset:2048 sc1
  s_mov_b64 exec, -1
  s_branch BACK_43
AGAIN_48:
  s_waitcnt vmcnt(6)
  s_mov_b64 exec, s[56:57]
  global_load_dwordx4 v[4:7], v19, s[40:41] offset:2048 sc1
  global_load_dwordx4 v[8:11], v19, s[40:41] offset:3072 sc1
  s_mov_b64 exec, -1
  global_load_dwordx4 v[32:35], v27, s[42:43] offset:0 sc1
  global_load_dwordx4 v[36:39], v27, s[42:43] offset:512 sc1
  global_load_dwordx4 v[40:43], v27, s[42:43] offset:1024 sc1
  global_load_dwordx4 v[44:47], v27, s[42:43] offset:1536 sc1
  s_add_u32 s33, s33, 1
  s_cmp_gt_u32 s33, 400000
  s_cbranch_scc1 L_exit
  s_branch COMP_44
RETRY_45:
  s_cmp_eq_u32 s64, 0
  s_cbranch_scc1 POLL_47
  s_cmp_eq_u32 s31, 0
  s_branch OK_46
POLL_47:
  s_mov_b64 exec, s[56:57]
  global_load_dwordx4 v[4:7], v19, s[40:41] offset:2048 sc1
  global_load_dwordx4 v[8:11], v19, s[40:41] offset:3072 sc1
  s_mov_b64 exec, -1
  global_load_dwordx4 v[32:35], v27, s[42:43] offset:0 sc1
  global_load_dwordx4 v[36:39], v27, s[42:43] offset:512 sc1
  global_load_dwordx4 v[40:43], v27, s[42:43] offset:1024 sc1
  global_load_dwordx4 v[44:47], v27, s[42:43] offset:1536 sc1
  s_add_u32 s33, s33, 1
  s_cmp_gt_u32 s33, 400000
  s_cbranch_scc1 L_exit
  v_max3_u32 v2, v32, v33, v34
  v_max3_u32 v2, v35, v36, v2
  v_max3_u32 v2, v37, v38, v2
  v_max3_u32 v2, v39, v40, v2
  v_max3_u32 v2, v41, v42, v2
  v_max3_u32 v2, v43, v44, v2
  v_max3_u32 v2, v45, v46, v2
  v_max3_u32 v2, v47, v4, v2
  v_max3_u32 v2, v5, v6, v2
  v_max3_u32 v2, v7, v8, v2
  v_max3_u32 v2, v9, v10, v2
  v_max_u32 v2, v11, v2
  v_cmp_eq_u32 vcc, -1, v2
  s_cbranch_vccnz COMP_44
  s_mov_b32 s64, 1
  s_branch COMP_44
SLOW_50:
  global_store_dwordx2 v25, v[48:49], s[26:27] sc1
  s_branch BACK_51
L_end:
.section .rodata,"a"
.p2align 6
.amdhsa_kernel interleave_layers__sliding_block_cached__glu_gated_glu__decode_kernel
  .amdhsa_next_free_vgpr 256
  .amdhsa_next_free_sgpr 102
  .amdhsa_accum_offset 256
  .amdhsa_group_segment_fixed_size 0
  .amdhsa_kernarg_size 96
  .amdhsa_user_sgpr_count 2
  .amdhsa_user_sgpr_kernarg_segment_ptr 1
  .amdhsa_system_sgpr_workgroup_id_x 1
.end_amdhsa_kernel
```
